```python
import torch

def _softmax(x, axis=-1):
    return torch.softmax(x, dim=axis)
def _gelu(x):
    return torch.nn.functional.gelu(x, approximate="tanh")
def _silu(x):
    return torch.nn.functional.silu(x)
def _sigmoid(x):
    return torch.sigmoid(x)
def _layernorm(x, axis=-1, eps=1e-5):
    m = x.mean(dim=axis, keepdim=True)
    v = x.var(dim=axis, keepdim=True, unbiased=False)
    return (x - m) / torch.sqrt(v + eps)
def _scatter_add(tgt, idx, src, axis=0):
    return tgt.clone().index_add_(axis, idx, src)
def _segment_sum(src, seg, n):
    out = torch.zeros((n,) + src.shape[1:], dtype=src.dtype)
    return out.index_add_(0, seg, src)
def _pad(x, pw):
    flat = tuple(v for pair in reversed(pw) for v in pair)
    return torch.nn.functional.pad(x, flat)

kernel_name = 'concat_heads__ssm_conv_h3__spectral_fnet__prompt'

def setup_inputs():

    _w = (lambda a: (lambda t: t.to(torch.bfloat16) if t.is_floating_point() else t)(torch.as_tensor(a)))
    def _A_setup():
        B, S, D = 1, 2048, 640
        ks = 4
        return {
            "q": _w((lambda *s: torch.randn(*s, dtype=torch.bfloat16) * 0.05)(B, S, D)),
            "k": _w((lambda *s: torch.randn(*s, dtype=torch.bfloat16) * 3.2)(B, S, D)),
            "v": _w((lambda *s: torch.randn(*s, dtype=torch.bfloat16) * 3.2)(B, S, D)),
            "shift_k": _w((lambda *s: torch.randn(*s, dtype=torch.bfloat16) * 3.2)(D, ks) * 0.5),
            "ssm_k": _w((lambda *s: torch.randn(*s, dtype=torch.bfloat16) * 3.2)(D, S) * (1.0 / S ** 0.5)),
            "ssm_D": _w((lambda *s: torch.randn(*s, dtype=torch.bfloat16) * 3.2)(D)),
        }
    _A_in = _A_setup()

    def _B_setup():
        B, S, D = 1, 2048, 640
        ns = torch.arange(S)[:, None] * torch.arange(S)[None, :]
        nd = torch.arange(D)[:, None] * torch.arange(D)[None, :]
        Ws_re = torch.cos(-2.0 * torch.pi * ns / S).to(float)
        Ws_im = torch.sin(-2.0 * torch.pi * ns / S).to(float)
        Wd_re = torch.cos(-2.0 * torch.pi * nd / D).to(float)
        Wd_im = torch.sin(-2.0 * torch.pi * nd / D).to(float)
        return {
            "x": _w((lambda *s: torch.randn(*s, dtype=torch.bfloat16) * 0.05)(B, S, D)),
            "dft_seq_re": _w(Ws_re),
            "dft_seq_im": _w(Ws_im),
            "dft_hid_re": _w(Wd_re),
            "dft_hid_im": _w(Wd_im),
        }
    _B_in = _B_setup()

    return {
        "A_q": _A_in["q"],
        "A_k": _A_in["k"],
        "A_v": _A_in["v"],
        "A_shift_k": _A_in["shift_k"],
        "A_ssm_k": _A_in["ssm_k"],
        "A_ssm_D": _A_in["ssm_D"],
        "B_x": _B_in["x"],
        "B_dft_seq_re": _B_in["dft_seq_re"],
        "B_dft_seq_im": _B_in["dft_seq_im"],
        "B_dft_hid_re": _B_in["dft_hid_re"],
        "B_dft_hid_im": _B_in["dft_hid_im"],
    }

def reference(A_q, A_k, A_v, A_shift_k, A_ssm_k, A_ssm_D, B_x, B_dft_seq_re, B_dft_seq_im, B_dft_hid_re, B_dft_hid_im):
    def _A_ref(q, k, v, shift_k, ssm_k, ssm_D):
        B, S, D = q.shape
        ks = shift_k.shape[-1]
        k_pad = _pad(k, ((0, 0), (ks - 1, 0), (0, 0)))
        k_shift = torch.zeros_like(k)
        for t in range(ks):
            k_shift = k_shift + k_pad[:, t:t + S, :] * shift_k[:, ks - 1 - t][None, None, :]
        kv = k_shift * v
        L = 2 * S
        kv_pad = _pad(kv, ((0, 0), (0, S), (0, 0)))
        kf_pad = _pad(ssm_k, ((0, 0), (0, S)))
        kv_f = (lambda x, axes=(-2,-1): torch.fft.rfft2(x.float(), dim=axes))(kv_pad[:, None, :, :], axes=(1, 2))
        kf_f = (lambda x, axes=(-2,-1): torch.fft.rfft2(x.float(), dim=axes))(kf_pad[:, None, :], axes=(1, 2))
        kf_f = (lambda x, *d: x.permute(*d))(kf_f, 1, 2, 0)
        y_f = kv_f * kf_f[None, :, :, :]
        y = (lambda x, s, axes=(-2,-1): torch.fft.irfft2(x, s=s, dim=axes).to(torch.bfloat16))(y_f, (1, L), axes=(1, 2))[:, 0, :S, :]
        y = y + kv * ssm_D[None, None, :]
        return q * y

    def _B_ref(x, dft_seq_re, dft_seq_im, dft_hid_re, dft_hid_im):
        a = torch.einsum("bsd,ed->bse", x, dft_hid_re)
        b = torch.einsum("bsd,ed->bse", x, dft_hid_im)
        y = torch.einsum("ts,bse->bte", dft_seq_re, a) - torch.einsum("ts,bse->bte", dft_seq_im, b)
        return y

    a = _A_ref(A_q, A_k, A_v, A_shift_k, A_ssm_k, A_ssm_D)
    b = _B_ref(B_x, B_dft_seq_re, B_dft_seq_im, B_dft_hid_re, B_dft_hid_im)
    return torch.concatenate([a, b], axis=-1)
```

```asm
; @launch kernel=k1_kernel grid=(320,1,1) block=(256,1,1) lds=153920
; @launch kernel=k2_kernel grid=(256,1,1) block=(256,1,1) lds=110592
; @launch kernel=k3_kernel grid=(640,1,1) block=(256,1,1) lds=0
.amdgcn_target "amdgcn-amd-amdhsa--gfx950"
.text
.globl k1_kernel
.p2align 8
.type k1_kernel,@function
k1_kernel:
    s_cmp_ge_u32 s2, 320
    s_cbranch_scc1 L_k1_end
    s_cmp_ge_u32 s2, 160
    s_cbranch_scc1 L_stage1
    s_and_b32 s3, s2, 7
    s_mul_i32 s3, s3, 20
    s_lshr_b32 s2, s2, 3
    s_add_u32 s2, s2, s3
    s_load_dwordx4 s[4:7], s[0:1], 0
    s_load_dwordx4 s[40:43], s[0:1], 16
    s_load_dwordx4 s[44:47], s[0:1], 32
    s_load_dwordx2 s[48:49], s[0:1], 88
    s_waitcnt lgkmcnt(0)
    s_mov_b32 s8, s4
    s_mov_b32 s9, s5
    s_mov_b32 s10, 2621440
    s_mov_b32 s11, 0x00020000
    s_mov_b32 s12, s6
    s_mov_b32 s13, s7
    s_mov_b32 s14, 2621440
    s_mov_b32 s15, 0x00020000
    s_mov_b32 s16, s40
    s_mov_b32 s17, s41
    s_mov_b32 s18, 2621440
    s_mov_b32 s19, 0x00020000
    s_mov_b32 s52, s44
    s_mov_b32 s53, s45
    s_mov_b32 s54, 2621440
    s_mov_b32 s55, 0x00020000
    s_mov_b32 s56, s48
    s_mov_b32 s57, s49
    s_mov_b32 s58, 5242880
    s_mov_b32 s59, 0x00020000
    s_lshl_b32 s3, s2, 5
    s_add_u32 s42, s42, s3
    s_addc_u32 s43, s43, 0
    s_load_dwordx8 s[60:67], s[42:43], 0
    s_lshl_b32 s3, s2, 3
    s_add_u32 s46, s46, s3
    s_addc_u32 s47, s47, 0
    s_load_dwordx2 s[68:69], s[46:47], 0
    v_lshrrev_b32 v1, 6, v0
    s_nop 1
    v_readfirstlane_b32 s22, v1
    v_and_b32 v2, 63, v0
    s_movk_i32 s23, 0x2800
    v_mul_lo_u32 v3, v0, s23
    v_add_u32 v3, s3, v3
    v_add_u32 v4, 4294963456, v3
    buffer_load_dwordx2 v[20:21], v4, s[12:15], 0 offen
    v_add_u32 v4, 4294964736, v3
    buffer_load_dwordx2 v[22:23], v4, s[12:15], 0 offen
    v_add_u32 v4, 4294966016, v3
    buffer_load_dwordx2 v[24:25], v4, s[12:15], 0 offen
    v_add_u32 v4, 0, v3
    buffer_load_dwordx2 v[26:27], v4, s[12:15], 0 offen
    v_add_u32 v4, 1280, v3
    buffer_load_dwordx2 v[28:29], v4, s[12:15], 0 offen
    v_add_u32 v4, 2560, v3
    buffer_load_dwordx2 v[30:31], v4, s[12:15], 0 offen
    v_add_u32 v4, 3840, v3
    buffer_load_dwordx2 v[32:33], v4, s[12:15], 0 offen
    v_add_u32 v4, 5120, v3
    buffer_load_dwordx2 v[34:35], v4, s[12:15], 0 offen
    v_add_u32 v4, 6400, v3
    buffer_load_dwordx2 v[36:37], v4, s[12:15], 0 offen
    v_add_u32 v4, 7680, v3
    buffer_load_dwordx2 v[38:39], v4, s[12:15], 0 offen
    v_add_u32 v4, 8960, v3
    buffer_load_dwordx2 v[40:41], v4, s[12:15], 0 offen
    v_add_u32 v4, 0, v3
    buffer_load_dwordx2 v[42:43], v4, s[16:19], 0 offen
    v_add_u32 v4, 1280, v3
    buffer_load_dwordx2 v[44:45], v4, s[16:19], 0 offen
    v_add_u32 v4, 2560, v3
    buffer_load_dwordx2 v[46:47], v4, s[16:19], 0 offen
    v_add_u32 v4, 3840, v3
    buffer_load_dwordx2 v[48:49], v4, s[16:19], 0 offen
    v_add_u32 v4, 5120, v3
    buffer_load_dwordx2 v[50:51], v4, s[16:19], 0 offen
    v_add_u32 v4, 6400, v3
    buffer_load_dwordx2 v[52:53], v4, s[16:19], 0 offen
    v_add_u32 v4, 7680, v3
    buffer_load_dwordx2 v[54:55], v4, s[16:19], 0 offen
    v_add_u32 v4, 8960, v3
    buffer_load_dwordx2 v[56:57], v4, s[16:19], 0 offen
    v_add_u32 v4, 0, v3
    buffer_load_dwordx2 v[58:59], v4, s[8:11], 0 offen
    v_add_u32 v4, 1280, v3
    buffer_load_dwordx2 v[60:61], v4, s[8:11], 0 offen
    v_add_u32 v4, 2560, v3
    buffer_load_dwordx2 v[62:63], v4, s[8:11], 0 offen
    v_add_u32 v4, 3840, v3
    buffer_load_dwordx2 v[64:65], v4, s[8:11], 0 offen
    v_add_u32 v4, 5120, v3
    buffer_load_dwordx2 v[66:67], v4, s[8:11], 0 offen
    v_add_u32 v4, 6400, v3
    buffer_load_dwordx2 v[68:69], v4, s[8:11], 0 offen
    v_add_u32 v4, 7680, v3
    buffer_load_dwordx2 v[70:71], v4, s[8:11], 0 offen
    v_add_u32 v4, 8960, v3
    buffer_load_dwordx2 v[72:73], v4, s[8:11], 0 offen
    s_lshl_b32 s24, s2, 2
    s_add_u32 s24, s24, s22
    s_lshl_b32 s24, s24, 12
    s_add_u32 s24, s24, 4016
    v_lshlrev_b32 v4, 6, v2
    v_sub_u32 v4, s24, v4
    v_cmp_eq_u32 vcc, 63, v2
    v_bfrev_b32 v6, 1
    s_nop 1
    v_cndmask_b32 v5, v4, v6, vcc
    buffer_load_dwordx4 v[100:103], v5, s[52:55], 0 offen
    buffer_load_dwordx4 v[104:107], v4, s[52:55], 0 offen offset:16
    buffer_load_dwordx4 v[108:111], v4, s[52:55], 0 offen offset:32
    buffer_load_dwordx4 v[112:115], v4, s[52:55], 0 offen offset:48
    buffer_load_dwordx4 v[116:119], v4, s[52:55], 0 offen offset:64
    s_waitcnt lgkmcnt(0)
    s_lshl_b32 s70, s60, 16
    s_and_b32 s71, s60, 0xffff0000
    s_lshl_b32 s72, s61, 16
    s_and_b32 s73, s61, 0xffff0000
    s_lshl_b32 s74, s62, 16
    s_and_b32 s75, s62, 0xffff0000
    s_lshl_b32 s76, s63, 16
    s_and_b32 s77, s63, 0xffff0000
    s_lshl_b32 s78, s64, 16
    s_and_b32 s79, s64, 0xffff0000
    s_lshl_b32 s80, s65, 16
    s_and_b32 s81, s65, 0xffff0000
    s_lshl_b32 s82, s66, 16
    s_and_b32 s83, s66, 0xffff0000
    s_lshl_b32 s84, s67, 16
    s_and_b32 s85, s67, 0xffff0000
    s_lshl_b32 s86, s68, 16
    s_and_b32 s87, s68, 0xffff0000
    s_lshl_b32 s88, s69, 16
    s_and_b32 s89, s69, 0xffff0000
    s_waitcnt vmcnt(13)
    v_lshlrev_b32 v80, 16, v20
    v_lshlrev_b32 v81, 16, v22
    v_lshlrev_b32 v82, 16, v24
    v_lshlrev_b32 v83, 16, v26
    v_lshlrev_b32 v84, 16, v28
    v_lshlrev_b32 v85, 16, v30
    v_lshlrev_b32 v86, 16, v32
    v_lshlrev_b32 v87, 16, v34
    v_lshlrev_b32 v88, 16, v36
    v_lshlrev_b32 v89, 16, v38
    v_lshlrev_b32 v90, 16, v40
    v_mul_f32 v7, s73, v80
    v_cvt_pk_bf16_f32 v7, v7, v7
    v_lshlrev_b32 v7, 16, v7
    v_mul_f32 v8, s72, v81
    v_cvt_pk_bf16_f32 v8, v8, v8
    v_lshlrev_b32 v8, 16, v8
    v_add_f32 v7, v7, v8
    v_cvt_pk_bf16_f32 v7, v7, v7
    v_lshlrev_b32 v7, 16, v7
    v_mul_f32 v8, s71, v82
    v_cvt_pk_bf16_f32 v8, v8, v8
    v_lshlrev_b32 v8, 16, v8
    v_add_f32 v7, v7, v8
    v_cvt_pk_bf16_f32 v7, v7, v7
    v_lshlrev_b32 v7, 16, v7
    v_mul_f32 v8, s70, v83
    v_cvt_pk_bf16_f32 v8, v8, v8
    v_lshlrev_b32 v8, 16, v8
    v_add_f32 v7, v7, v8
    v_cvt_pk_bf16_f32 v7, v7, v7
    v_lshlrev_b32 v7, 16, v7
    v_lshlrev_b32 v8, 16, v42
    v_mul_f32 v7, v7, v8
    v_cvt_pk_bf16_f32 v130, v7, v7
    v_lshlrev_b32 v130, 16, v130
    v_mul_f32 v7, s73, v81
    v_cvt_pk_bf16_f32 v7, v7, v7
    v_lshlrev_b32 v7, 16, v7
    v_mul_f32 v8, s72, v82
    v_cvt_pk_bf16_f32 v8, v8, v8
    v_lshlrev_b32 v8, 16, v8
    v_add_f32 v7, v7, v8
    v_cvt_pk_bf16_f32 v7, v7, v7
    v_lshlrev_b32 v7, 16, v7
    v_mul_f32 v8, s71, v83
    v_cvt_pk_bf16_f32 v8, v8, v8
    v_lshlrev_b32 v8, 16, v8
    v_add_f32 v7, v7, v8
    v_cvt_pk_bf16_f32 v7, v7, v7
    v_lshlrev_b32 v7, 16, v7
    v_mul_f32 v8, s70, v84
    v_cvt_pk_bf16_f32 v8, v8, v8
    v_lshlrev_b32 v8, 16, v8
    v_add_f32 v7, v7, v8
    v_cvt_pk_bf16_f32 v7, v7, v7
    v_lshlrev_b32 v7, 16, v7
    v_lshlrev_b32 v8, 16, v44
    v_mul_f32 v7, v7, v8
    v_cvt_pk_bf16_f32 v131, v7, v7
    v_lshlrev_b32 v131, 16, v131
    v_mul_f32 v7, s73, v82
    v_cvt_pk_bf16_f32 v7, v7, v7
    v_lshlrev_b32 v7, 16, v7
    v_mul_f32 v8, s72, v83
    v_cvt_pk_bf16_f32 v8, v8, v8
    v_lshlrev_b32 v8, 16, v8
    v_add_f32 v7, v7, v8
    v_cvt_pk_bf16_f32 v7, v7, v7
    v_lshlrev_b32 v7, 16, v7
    v_mul_f32 v8, s71, v84
    v_cvt_pk_bf16_f32 v8, v8, v8
    v_lshlrev_b32 v8, 16, v8
    v_add_f32 v7, v7, v8
    v_cvt_pk_bf16_f32 v7, v7, v7
    v_lshlrev_b32 v7, 16, v7
    v_mul_f32 v8, s70, v85
    v_cvt_pk_bf16_f32 v8, v8, v8
    v_lshlrev_b32 v8, 16, v8
    v_add_f32 v7, v7, v8
    v_cvt_pk_bf16_f32 v7, v7, v7
    v_lshlrev_b32 v7, 16, v7
    v_lshlrev_b32 v8, 16, v46
    v_mul_f32 v7, v7, v8
    v_cvt_pk_bf16_f32 v132, v7, v7
    v_lshlrev_b32 v132, 16, v132
    v_mul_f32 v7, s73, v83
    v_cvt_pk_bf16_f32 v7, v7, v7
    v_lshlrev_b32 v7, 16, v7
    v_mul_f32 v8, s72, v84
    v_cvt_pk_bf16_f32 v8, v8, v8
    v_lshlrev_b32 v8, 16, v8
    v_add_f32 v7, v7, v8
    v_cvt_pk_bf16_f32 v7, v7, v7
    v_lshlrev_b32 v7, 16, v7
    v_mul_f32 v8, s71, v85
    v_cvt_pk_bf16_f32 v8, v8, v8
    v_lshlrev_b32 v8, 16, v8
    v_add_f32 v7, v7, v8
    v_cvt_pk_bf16_f32 v7, v7, v7
    v_lshlrev_b32 v7, 16, v7
    v_mul_f32 v8, s70, v86
    v_cvt_pk_bf16_f32 v8, v8, v8
    v_lshlrev_b32 v8, 16, v8
    v_add_f32 v7, v7, v8
    v_cvt_pk_bf16_f32 v7, v7, v7
    v_lshlrev_b32 v7, 16, v7
    v_lshlrev_b32 v8, 16, v48
    v_mul_f32 v7, v7, v8
    v_cvt_pk_bf16_f32 v133, v7, v7
    v_lshlrev_b32 v133, 16, v133
    v_mul_f32 v7, s73, v84
    v_cvt_pk_bf16_f32 v7, v7, v7
    v_lshlrev_b32 v7, 16, v7
    v_mul_f32 v8, s72, v85
    v_cvt_pk_bf16_f32 v8, v8, v8
    v_lshlrev_b32 v8, 16, v8
    v_add_f32 v7, v7, v8
    v_cvt_pk_bf16_f32 v7, v7, v7
    v_lshlrev_b32 v7, 16, v7
    v_mul_f32 v8, s71, v86
    v_cvt_pk_bf16_f32 v8, v8, v8
    v_lshlrev_b32 v8, 16, v8
    v_add_f32 v7, v7, v8
    v_cvt_pk_bf16_f32 v7, v7, v7
    v_lshlrev_b32 v7, 16, v7
    v_mul_f32 v8, s70, v87
    v_cvt_pk_bf16_f32 v8, v8, v8
    v_lshlrev_b32 v8, 16, v8
    v_add_f32 v7, v7, v8
    v_cvt_pk_bf16_f32 v7, v7, v7
    v_lshlrev_b32 v7, 16, v7
    v_lshlrev_b32 v8, 16, v50
    v_mul_f32 v7, v7, v8
    v_cvt_pk_bf16_f32 v134, v7, v7
    v_lshlrev_b32 v134, 16, v134
    v_mul_f32 v7, s73, v85
    v_cvt_pk_bf16_f32 v7, v7, v7
    v_lshlrev_b32 v7, 16, v7
    v_mul_f32 v8, s72, v86
    v_cvt_pk_bf16_f32 v8, v8, v8
    v_lshlrev_b32 v8, 16, v8
    v_add_f32 v7, v7, v8
    v_cvt_pk_bf16_f32 v7, v7, v7
    v_lshlrev_b32 v7, 16, v7
    v_mul_f32 v8, s71, v87
    v_cvt_pk_bf16_f32 v8, v8, v8
    v_lshlrev_b32 v8, 16, v8
    v_add_f32 v7, v7, v8
    v_cvt_pk_bf16_f32 v7, v7, v7
    v_lshlrev_b32 v7, 16, v7
    v_mul_f32 v8, s70, v88
    v_cvt_pk_bf16_f32 v8, v8, v8
    v_lshlrev_b32 v8, 16, v8
    v_add_f32 v7, v7, v8
    v_cvt_pk_bf16_f32 v7, v7, v7
    v_lshlrev_b32 v7, 16, v7
    v_lshlrev_b32 v8, 16, v52
    v_mul_f32 v7, v7, v8
    v_cvt_pk_bf16_f32 v135, v7, v7
    v_lshlrev_b32 v135, 16, v135
    v_mul_f32 v7, s73, v86
    v_cvt_pk_bf16_f32 v7, v7, v7
    v_lshlrev_b32 v7, 16, v7
    v_mul_f32 v8, s72, v87
    v_cvt_pk_bf16_f32 v8, v8, v8
    v_lshlrev_b32 v8, 16, v8
    v_add_f32 v7, v7, v8
    v_cvt_pk_bf16_f32 v7, v7, v7
    v_lshlrev_b32 v7, 16, v7
    v_mul_f32 v8, s71, v88
    v_cvt_pk_bf16_f32 v8, v8, v8
    v_lshlrev_b32 v8, 16, v8
    v_add_f32 v7, v7, v8
    v_cvt_pk_bf16_f32 v7, v7, v7
    v_lshlrev_b32 v7, 16, v7
    v_mul_f32 v8, s70, v89
    v_cvt_pk_bf16_f32 v8, v8, v8
    v_lshlrev_b32 v8, 16, v8
    v_add_f32 v7, v7, v8
    v_cvt_pk_bf16_f32 v7, v7, v7
    v_lshlrev_b32 v7, 16, v7
    v_lshlrev_b32 v8, 16, v54
    v_mul_f32 v7, v7, v8
    v_cvt_pk_bf16_f32 v136, v7, v7
    v_lshlrev_b32 v136, 16, v136
    v_mul_f32 v7, s73, v87
    v_cvt_pk_bf16_f32 v7, v7, v7
    v_lshlrev_b32 v7, 16, v7
    v_mul_f32 v8, s72, v88
    v_cvt_pk_bf16_f32 v8, v8, v8
    v_lshlrev_b32 v8, 16, v8
    v_add_f32 v7, v7, v8
    v_cvt_pk_bf16_f32 v7, v7, v7
    v_lshlrev_b32 v7, 16, v7
    v_mul_f32 v8, s71, v89
    v_cvt_pk_bf16_f32 v8, v8, v8
    v_lshlrev_b32 v8, 16, v8
    v_add_f32 v7, v7, v8
    v_cvt_pk_bf16_f32 v7, v7, v7
    v_lshlrev_b32 v7, 16, v7
    v_mul_f32 v8, s70, v90
    v_cvt_pk_bf16_f32 v8, v8, v8
    v_lshlrev_b32 v8, 16, v8
    v_add_f32 v7, v7, v8
    v_cvt_pk_bf16_f32 v7, v7, v7
    v_lshlrev_b32 v7, 16, v7
    v_lshlrev_b32 v8, 16, v56
    v_mul_f32 v7, v7, v8
    v_cvt_pk_bf16_f32 v137, v7, v7
    v_lshlrev_b32 v137, 16, v137
    v_and_b32 v80, 0xffff0000, v20
    v_and_b32 v81, 0xffff0000, v22
    v_and_b32 v82, 0xffff0000, v24
    v_and_b32 v83, 0xffff0000, v26
    v_and_b32 v84, 0xffff0000, v28
    v_and_b32 v85, 0xffff0000, v30
    v_and_b32 v86, 0xffff0000, v32
    v_and_b32 v87, 0xffff0000, v34
    v_and_b32 v88, 0xffff0000, v36
    v_and_b32 v89, 0xffff0000, v38
    v_and_b32 v90, 0xffff0000, v40
    v_mul_f32 v7, s77, v80
    v_cvt_pk_bf16_f32 v7, v7, v7
    v_lshlrev_b32 v7, 16, v7
    v_mul_f32 v8, s76, v81
    v_cvt_pk_bf16_f32 v8, v8, v8
    v_lshlrev_b32 v8, 16, v8
    v_add_f32 v7, v7, v8
    v_cvt_pk_bf16_f32 v7, v7, v7
    v_lshlrev_b32 v7, 16, v7
    v_mul_f32 v8, s75, v82
    v_cvt_pk_bf16_f32 v8, v8, v8
    v_lshlrev_b32 v8, 16, v8
    v_add_f32 v7, v7, v8
    v_cvt_pk_bf16_f32 v7, v7, v7
    v_lshlrev_b32 v7, 16, v7
    v_mul_f32 v8, s74, v83
    v_cvt_pk_bf16_f32 v8, v8, v8
    v_lshlrev_b32 v8, 16, v8
    v_add_f32 v7, v7, v8
    v_cvt_pk_bf16_f32 v7, v7, v7
    v_lshlrev_b32 v7, 16, v7
    v_and_b32 v8, 0xffff0000, v42
    v_mul_f32 v7, v7, v8
    v_cvt_pk_bf16_f32 v138, v7, v7
    v_lshlrev_b32 v138, 16, v138
    v_mul_f32 v7, s77, v81
    v_cvt_pk_bf16_f32 v7, v7, v7
    v_lshlrev_b32 v7, 16, v7
    v_mul_f32 v8, s76, v82
    v_cvt_pk_bf16_f32 v8, v8, v8
    v_lshlrev_b32 v8, 16, v8
    v_add_f32 v7, v7, v8
    v_cvt_pk_bf16_f32 v7, v7, v7
    v_lshlrev_b32 v7, 16, v7
    v_mul_f32 v8, s75, v83
    v_cvt_pk_bf16_f32 v8, v8, v8
    v_lshlrev_b32 v8, 16, v8
    v_add_f32 v7, v7, v8
    v_cvt_pk_bf16_f32 v7, v7, v7
    v_lshlrev_b32 v7, 16, v7
    v_mul_f32 v8, s74, v84
    v_cvt_pk_bf16_f32 v8, v8, v8
    v_lshlrev_b32 v8, 16, v8
    v_add_f32 v7, v7, v8
    v_cvt_pk_bf16_f32 v7, v7, v7
    v_lshlrev_b32 v7, 16, v7
    v_and_b32 v8, 0xffff0000, v44
    v_mul_f32 v7, v7, v8
    v_cvt_pk_bf16_f32 v139, v7, v7
    v_lshlrev_b32 v139, 16, v139
    v_mul_f32 v7, s77, v82
    v_cvt_pk_bf16_f32 v7, v7, v7
    v_lshlrev_b32 v7, 16, v7
    v_mul_f32 v8, s76, v83
    v_cvt_pk_bf16_f32 v8, v8, v8
    v_lshlrev_b32 v8, 16, v8
    v_add_f32 v7, v7, v8
    v_cvt_pk_bf16_f32 v7, v7, v7
    v_lshlrev_b32 v7, 16, v7
    v_mul_f32 v8, s75, v84
    v_cvt_pk_bf16_f32 v8, v8, v8
    v_lshlrev_b32 v8, 16, v8
    v_add_f32 v7, v7, v8
    v_cvt_pk_bf16_f32 v7, v7, v7
    v_lshlrev_b32 v7, 16, v7
    v_mul_f32 v8, s74, v85
    v_cvt_pk_bf16_f32 v8, v8, v8
    v_lshlrev_b32 v8, 16, v8
    v_add_f32 v7, v7, v8
    v_cvt_pk_bf16_f32 v7, v7, v7
    v_lshlrev_b32 v7, 16, v7
    v_and_b32 v8, 0xffff0000, v46
    v_mul_f32 v7, v7, v8
    v_cvt_pk_bf16_f32 v140, v7, v7
    v_lshlrev_b32 v140, 16, v140
    v_mul_f32 v7, s77, v83
    v_cvt_pk_bf16_f32 v7, v7, v7
    v_lshlrev_b32 v7, 16, v7
    v_mul_f32 v8, s76, v84
    v_cvt_pk_bf16_f32 v8, v8, v8
    v_lshlrev_b32 v8, 16, v8
    v_add_f32 v7, v7, v8
    v_cvt_pk_bf16_f32 v7, v7, v7
    v_lshlrev_b32 v7, 16, v7
    v_mul_f32 v8, s75, v85
    v_cvt_pk_bf16_f32 v8, v8, v8
    v_lshlrev_b32 v8, 16, v8
    v_add_f32 v7, v7, v8
    v_cvt_pk_bf16_f32 v7, v7, v7
    v_lshlrev_b32 v7, 16, v7
    v_mul_f32 v8, s74, v86
    v_cvt_pk_bf16_f32 v8, v8, v8
    v_lshlrev_b32 v8, 16, v8
    v_add_f32 v7, v7, v8
    v_cvt_pk_bf16_f32 v7, v7, v7
    v_lshlrev_b32 v7, 16, v7
    v_and_b32 v8, 0xffff0000, v48
    v_mul_f32 v7, v7, v8
    v_cvt_pk_bf16_f32 v141, v7, v7
    v_lshlrev_b32 v141, 16, v141
    v_mul_f32 v7, s77, v84
    v_cvt_pk_bf16_f32 v7, v7, v7
    v_lshlrev_b32 v7, 16, v7
    v_mul_f32 v8, s76, v85
    v_cvt_pk_bf16_f32 v8, v8, v8
    v_lshlrev_b32 v8, 16, v8
    v_add_f32 v7, v7, v8
    v_cvt_pk_bf16_f32 v7, v7, v7
    v_lshlrev_b32 v7, 16, v7
    v_mul_f32 v8, s75, v86
    v_cvt_pk_bf16_f32 v8, v8, v8
    v_lshlrev_b32 v8, 16, v8
    v_add_f32 v7, v7, v8
    v_cvt_pk_bf16_f32 v7, v7, v7
    v_lshlrev_b32 v7, 16, v7
    v_mul_f32 v8, s74, v87
    v_cvt_pk_bf16_f32 v8, v8, v8
    v_lshlrev_b32 v8, 16, v8
    v_add_f32 v7, v7, v8
    v_cvt_pk_bf16_f32 v7, v7, v7
    v_lshlrev_b32 v7, 16, v7
    v_and_b32 v8, 0xffff0000, v50
    v_mul_f32 v7, v7, v8
    v_cvt_pk_bf16_f32 v142, v7, v7
    v_lshlrev_b32 v142, 16, v142
    v_mul_f32 v7, s77, v85
    v_cvt_pk_bf16_f32 v7, v7, v7
    v_lshlrev_b32 v7, 16, v7
    v_mul_f32 v8, s76, v86
    v_cvt_pk_bf16_f32 v8, v8, v8
    v_lshlrev_b32 v8, 16, v8
    v_add_f32 v7, v7, v8
    v_cvt_pk_bf16_f32 v7, v7, v7
    v_lshlrev_b32 v7, 16, v7
    v_mul_f32 v8, s75, v87
    v_cvt_pk_bf16_f32 v8, v8, v8
    v_lshlrev_b32 v8, 16, v8
    v_add_f32 v7, v7, v8
    v_cvt_pk_bf16_f32 v7, v7, v7
    v_lshlrev_b32 v7, 16, v7
    v_mul_f32 v8, s74, v88
    v_cvt_pk_bf16_f32 v8, v8, v8
    v_lshlrev_b32 v8, 16, v8
    v_add_f32 v7, v7, v8
    v_cvt_pk_bf16_f32 v7, v7, v7
    v_lshlrev_b32 v7, 16, v7
    v_and_b32 v8, 0xffff0000, v52
    v_mul_f32 v7, v7, v8
    v_cvt_pk_bf16_f32 v143, v7, v7
    v_lshlrev_b32 v143, 16, v143
    v_mul_f32 v7, s77, v86
    v_cvt_pk_bf16_f32 v7, v7, v7
    v_lshlrev_b32 v7, 16, v7
    v_mul_f32 v8, s76, v87
    v_cvt_pk_bf16_f32 v8, v8, v8
    v_lshlrev_b32 v8, 16, v8
    v_add_f32 v7, v7, v8
    v_cvt_pk_bf16_f32 v7, v7, v7
    v_lshlrev_b32 v7, 16, v7
    v_mul_f32 v8, s75, v88
    v_cvt_pk_bf16_f32 v8, v8, v8
    v_lshlrev_b32 v8, 16, v8
    v_add_f32 v7, v7, v8
    v_cvt_pk_bf16_f32 v7, v7, v7
    v_lshlrev_b32 v7, 16, v7
    v_mul_f32 v8, s74, v89
    v_cvt_pk_bf16_f32 v8, v8, v8
    v_lshlrev_b32 v8, 16, v8
    v_add_f32 v7, v7, v8
    v_cvt_pk_bf16_f32 v7, v7, v7
    v_lshlrev_b32 v7, 16, v7
    v_and_b32 v8, 0xffff0000, v54
    v_mul_f32 v7, v7, v8
    v_cvt_pk_bf16_f32 v144, v7, v7
    v_lshlrev_b32 v144, 16, v144
    v_mul_f32 v7, s77, v87
    v_cvt_pk_bf16_f32 v7, v7, v7
    v_lshlrev_b32 v7, 16, v7
    v_mul_f32 v8, s76, v88
    v_cvt_pk_bf16_f32 v8, v8, v8
    v_lshlrev_b32 v8, 16, v8
    v_add_f32 v7, v7, v8
    v_cvt_pk_bf16_f32 v7, v7, v7
    v_lshlrev_b32 v7, 16, v7
    v_mul_f32 v8, s75, v89
    v_cvt_pk_bf16_f32 v8, v8, v8
    v_lshlrev_b32 v8, 16, v8
    v_add_f32 v7, v7, v8
    v_cvt_pk_bf16_f32 v7, v7, v7
    v_lshlrev_b32 v7, 16, v7
    v_mul_f32 v8, s74, v90
    v_cvt_pk_bf16_f32 v8, v8, v8
    v_lshlrev_b32 v8, 16, v8
    v_add_f32 v7, v7, v8
    v_cvt_pk_bf16_f32 v7, v7, v7
    v_lshlrev_b32 v7, 16, v7
    v_and_b32 v8, 0xffff0000, v56
    v_mul_f32 v7, v7, v8
    v_cvt_pk_bf16_f32 v145, v7, v7
    v_lshlrev_b32 v145, 16, v145
    v_lshlrev_b32 v80, 16, v21
    v_lshlrev_b32 v81, 16, v23
    v_lshlrev_b32 v82, 16, v25
    v_lshlrev_b32 v83, 16, v27
    v_lshlrev_b32 v84, 16, v29
    v_lshlrev_b32 v85, 16, v31
    v_lshlrev_b32 v86, 16, v33
    v_lshlrev_b32 v87, 16, v35
    v_lshlrev_b32 v88, 16, v37
    v_lshlrev_b32 v89, 16, v39
    v_lshlrev_b32 v90, 16, v41
    v_mul_f32 v7, s81, v80
    v_cvt_pk_bf16_f32 v7, v7, v7
    v_lshlrev_b32 v7, 16, v7
    v_mul_f32 v8, s80, v81
    v_cvt_pk_bf16_f32 v8, v8, v8
    v_lshlrev_b32 v8, 16, v8
    v_add_f32 v7, v7, v8
    v_cvt_pk_bf16_f32 v7, v7, v7
    v_lshlrev_b32 v7, 16, v7
    v_mul_f32 v8, s79, v82
    v_cvt_pk_bf16_f32 v8, v8, v8
    v_lshlrev_b32 v8, 16, v8
    v_add_f32 v7, v7, v8
    v_cvt_pk_bf16_f32 v7, v7, v7
    v_lshlrev_b32 v7, 16, v7
    v_mul_f32 v8, s78, v83
    v_cvt_pk_bf16_f32 v8, v8, v8
    v_lshlrev_b32 v8, 16, v8
    v_add_f32 v7, v7, v8
    v_cvt_pk_bf16_f32 v7, v7, v7
    v_lshlrev_b32 v7, 16, v7
    v_lshlrev_b32 v8, 16, v43
    v_mul_f32 v7, v7, v8
    v_cvt_pk_bf16_f32 v146, v7, v7
    v_lshlrev_b32 v146, 16, v146
    v_mul_f32 v7, s81, v81
    v_cvt_pk_bf16_f32 v7, v7, v7
    v_lshlrev_b32 v7, 16, v7
    v_mul_f32 v8, s80, v82
    v_cvt_pk_bf16_f32 v8, v8, v8
    v_lshlrev_b32 v8, 16, v8
    v_add_f32 v7, v7, v8
    v_cvt_pk_bf16_f32 v7, v7, v7
    v_lshlrev_b32 v7, 16, v7
    v_mul_f32 v8, s79, v83
    v_cvt_pk_bf16_f32 v8, v8, v8
    v_lshlrev_b32 v8, 16, v8
    v_add_f32 v7, v7, v8
    v_cvt_pk_bf16_f32 v7, v7, v7
    v_lshlrev_b32 v7, 16, v7
    v_mul_f32 v8, s78, v84
    v_cvt_pk_bf16_f32 v8, v8, v8
    v_lshlrev_b32 v8, 16, v8
    v_add_f32 v7, v7, v8
    v_cvt_pk_bf16_f32 v7, v7, v7
    v_lshlrev_b32 v7, 16, v7
    v_lshlrev_b32 v8, 16, v45
    v_mul_f32 v7, v7, v8
    v_cvt_pk_bf16_f32 v147, v7, v7
    v_lshlrev_b32 v147, 16, v147
    v_mul_f32 v7, s81, v82
    v_cvt_pk_bf16_f32 v7, v7, v7
    v_lshlrev_b32 v7, 16, v7
    v_mul_f32 v8, s80, v83
    v_cvt_pk_bf16_f32 v8, v8, v8
    v_lshlrev_b32 v8, 16, v8
    v_add_f32 v7, v7, v8
    v_cvt_pk_bf16_f32 v7, v7, v7
    v_lshlrev_b32 v7, 16, v7
    v_mul_f32 v8, s79, v84
    v_cvt_pk_bf16_f32 v8, v8, v8
    v_lshlrev_b32 v8, 16, v8
    v_add_f32 v7, v7, v8
    v_cvt_pk_bf16_f32 v7, v7, v7
    v_lshlrev_b32 v7, 16, v7
    v_mul_f32 v8, s78, v85
    v_cvt_pk_bf16_f32 v8, v8, v8
    v_lshlrev_b32 v8, 16, v8
    v_add_f32 v7, v7, v8
    v_cvt_pk_bf16_f32 v7, v7, v7
    v_lshlrev_b32 v7, 16, v7
    v_lshlrev_b32 v8, 16, v47
    v_mul_f32 v7, v7, v8
    v_cvt_pk_bf16_f32 v148, v7, v7
    v_lshlrev_b32 v148, 16, v148
    v_mul_f32 v7, s81, v83
    v_cvt_pk_bf16_f32 v7, v7, v7
    v_lshlrev_b32 v7, 16, v7
    v_mul_f32 v8, s80, v84
    v_cvt_pk_bf16_f32 v8, v8, v8
    v_lshlrev_b32 v8, 16, v8
    v_add_f32 v7, v7, v8
    v_cvt_pk_bf16_f32 v7, v7, v7
    v_lshlrev_b32 v7, 16, v7
    v_mul_f32 v8, s79, v85
    v_cvt_pk_bf16_f32 v8, v8, v8
    v_lshlrev_b32 v8, 16, v8
    v_add_f32 v7, v7, v8
    v_cvt_pk_bf16_f32 v7, v7, v7
    v_lshlrev_b32 v7, 16, v7
    v_mul_f32 v8, s78, v86
    v_cvt_pk_bf16_f32 v8, v8, v8
    v_lshlrev_b32 v8, 16, v8
    v_add_f32 v7, v7, v8
    v_cvt_pk_bf16_f32 v7, v7, v7
    v_lshlrev_b32 v7, 16, v7
    v_lshlrev_b32 v8, 16, v49
    v_mul_f32 v7, v7, v8
    v_cvt_pk_bf16_f32 v149, v7, v7
    v_lshlrev_b32 v149, 16, v149
    v_mul_f32 v7, s81, v84
    v_cvt_pk_bf16_f32 v7, v7, v7
    v_lshlrev_b32 v7, 16, v7
    v_mul_f32 v8, s80, v85
    v_cvt_pk_bf16_f32 v8, v8, v8
    v_lshlrev_b32 v8, 16, v8
    v_add_f32 v7, v7, v8
    v_cvt_pk_bf16_f32 v7, v7, v7
    v_lshlrev_b32 v7, 16, v7
    v_mul_f32 v8, s79, v86
    v_cvt_pk_bf16_f32 v8, v8, v8
    v_lshlrev_b32 v8, 16, v8
    v_add_f32 v7, v7, v8
    v_cvt_pk_bf16_f32 v7, v7, v7
    v_lshlrev_b32 v7, 16, v7
    v_mul_f32 v8, s78, v87
    v_cvt_pk_bf16_f32 v8, v8, v8
    v_lshlrev_b32 v8, 16, v8
    v_add_f32 v7, v7, v8
    v_cvt_pk_bf16_f32 v7, v7, v7
    v_lshlrev_b32 v7, 16, v7
    v_lshlrev_b32 v8, 16, v51
    v_mul_f32 v7, v7, v8
    v_cvt_pk_bf16_f32 v150, v7, v7
    v_lshlrev_b32 v150, 16, v150
    v_mul_f32 v7, s81, v85
    v_cvt_pk_bf16_f32 v7, v7, v7
    v_lshlrev_b32 v7, 16, v7
    v_mul_f32 v8, s80, v86
    v_cvt_pk_bf16_f32 v8, v8, v8
    v_lshlrev_b32 v8, 16, v8
    v_add_f32 v7, v7, v8
    v_cvt_pk_bf16_f32 v7, v7, v7
    v_lshlrev_b32 v7, 16, v7
    v_mul_f32 v8, s79, v87
    v_cvt_pk_bf16_f32 v8, v8, v8
    v_lshlrev_b32 v8, 16, v8
    v_add_f32 v7, v7, v8
    v_cvt_pk_bf16_f32 v7, v7, v7
    v_lshlrev_b32 v7, 16, v7
    v_mul_f32 v8, s78, v88
    v_cvt_pk_bf16_f32 v8, v8, v8
    v_lshlrev_b32 v8, 16, v8
    v_add_f32 v7, v7, v8
    v_cvt_pk_bf16_f32 v7, v7, v7
    v_lshlrev_b32 v7, 16, v7
    v_lshlrev_b32 v8, 16, v53
    v_mul_f32 v7, v7, v8
    v_cvt_pk_bf16_f32 v151, v7, v7
    v_lshlrev_b32 v151, 16, v151
    v_mul_f32 v7, s81, v86
    v_cvt_pk_bf16_f32 v7, v7, v7
    v_lshlrev_b32 v7, 16, v7
    v_mul_f32 v8, s80, v87
    v_cvt_pk_bf16_f32 v8, v8, v8
    v_lshlrev_b32 v8, 16, v8
    v_add_f32 v7, v7, v8
    v_cvt_pk_bf16_f32 v7, v7, v7
    v_lshlrev_b32 v7, 16, v7
    v_mul_f32 v8, s79, v88
    v_cvt_pk_bf16_f32 v8, v8, v8
    v_lshlrev_b32 v8, 16, v8
    v_add_f32 v7, v7, v8
    v_cvt_pk_bf16_f32 v7, v7, v7
    v_lshlrev_b32 v7, 16, v7
    v_mul_f32 v8, s78, v89
    v_cvt_pk_bf16_f32 v8, v8, v8
    v_lshlrev_b32 v8, 16, v8
    v_add_f32 v7, v7, v8
    v_cvt_pk_bf16_f32 v7, v7, v7
    v_lshlrev_b32 v7, 16, v7
    v_lshlrev_b32 v8, 16, v55
    v_mul_f32 v7, v7, v8
    v_cvt_pk_bf16_f32 v152, v7, v7
    v_lshlrev_b32 v152, 16, v152
    v_mul_f32 v7, s81, v87
    v_cvt_pk_bf16_f32 v7, v7, v7
    v_lshlrev_b32 v7, 16, v7
    v_mul_f32 v8, s80, v88
    v_cvt_pk_bf16_f32 v8, v8, v8
    v_lshlrev_b32 v8, 16, v8
    v_add_f32 v7, v7, v8
    v_cvt_pk_bf16_f32 v7, v7, v7
    v_lshlrev_b32 v7, 16, v7
    v_mul_f32 v8, s79, v89
    v_cvt_pk_bf16_f32 v8, v8, v8
    v_lshlrev_b32 v8, 16, v8
    v_add_f32 v7, v7, v8
    v_cvt_pk_bf16_f32 v7, v7, v7
    v_lshlrev_b32 v7, 16, v7
    v_mul_f32 v8, s78, v90
    v_cvt_pk_bf16_f32 v8, v8, v8
    v_lshlrev_b32 v8, 16, v8
    v_add_f32 v7, v7, v8
    v_cvt_pk_bf16_f32 v7, v7, v7
    v_lshlrev_b32 v7, 16, v7
    v_lshlrev_b32 v8, 16, v57
    v_mul_f32 v7, v7, v8
    v_cvt_pk_bf16_f32 v153, v7, v7
    v_lshlrev_b32 v153, 16, v153
    v_and_b32 v80, 0xffff0000, v21
    v_and_b32 v81, 0xffff0000, v23
    v_and_b32 v82, 0xffff0000, v25
    v_and_b32 v83, 0xffff0000, v27
    v_and_b32 v84, 0xffff0000, v29
    v_and_b32 v85, 0xffff0000, v31
    v_and_b32 v86, 0xffff0000, v33
    v_and_b32 v87, 0xffff0000, v35
    v_and_b32 v88, 0xffff0000, v37
    v_and_b32 v89, 0xffff0000, v39
    v_and_b32 v90, 0xffff0000, v41
    v_mul_f32 v7, s85, v80
    v_cvt_pk_bf16_f32 v7, v7, v7
    v_lshlrev_b32 v7, 16, v7
    v_mul_f32 v8, s84, v81
    v_cvt_pk_bf16_f32 v8, v8, v8
    v_lshlrev_b32 v8, 16, v8
    v_add_f32 v7, v7, v8
    v_cvt_pk_bf16_f32 v7, v7, v7
    v_lshlrev_b32 v7, 16, v7
    v_mul_f32 v8, s83, v82
    v_cvt_pk_bf16_f32 v8, v8, v8
    v_lshlrev_b32 v8, 16, v8
    v_add_f32 v7, v7, v8
    v_cvt_pk_bf16_f32 v7, v7, v7
    v_lshlrev_b32 v7, 16, v7
    v_mul_f32 v8, s82, v83
    v_cvt_pk_bf16_f32 v8, v8, v8
    v_lshlrev_b32 v8, 16, v8
    v_add_f32 v7, v7, v8
    v_cvt_pk_bf16_f32 v7, v7, v7
    v_lshlrev_b32 v7, 16, v7
    v_and_b32 v8, 0xffff0000, v43
    v_mul_f32 v7, v7, v8
    v_cvt_pk_bf16_f32 v154, v7, v7
    v_lshlrev_b32 v154, 16, v154
    v_mul_f32 v7, s85, v81
    v_cvt_pk_bf16_f32 v7, v7, v7
    v_lshlrev_b32 v7, 16, v7
    v_mul_f32 v8, s84, v82
    v_cvt_pk_bf16_f32 v8, v8, v8
    v_lshlrev_b32 v8, 16, v8
    v_add_f32 v7, v7, v8
    v_cvt_pk_bf16_f32 v7, v7, v7
    v_lshlrev_b32 v7, 16, v7
    v_mul_f32 v8, s83, v83
    v_cvt_pk_bf16_f32 v8, v8, v8
    v_lshlrev_b32 v8, 16, v8
    v_add_f32 v7, v7, v8
    v_cvt_pk_bf16_f32 v7, v7, v7
    v_lshlrev_b32 v7, 16, v7
    v_mul_f32 v8, s82, v84
    v_cvt_pk_bf16_f32 v8, v8, v8
    v_lshlrev_b32 v8, 16, v8
    v_add_f32 v7, v7, v8
    v_cvt_pk_bf16_f32 v7, v7, v7
    v_lshlrev_b32 v7, 16, v7
    v_and_b32 v8, 0xffff0000, v45
    v_mul_f32 v7, v7, v8
    v_cvt_pk_bf16_f32 v155, v7, v7
    v_lshlrev_b32 v155, 16, v155
    v_mul_f32 v7, s85, v82
    v_cvt_pk_bf16_f32 v7, v7, v7
    v_lshlrev_b32 v7, 16, v7
    v_mul_f32 v8, s84, v83
    v_cvt_pk_bf16_f32 v8, v8, v8
    v_lshlrev_b32 v8, 16, v8
    v_add_f32 v7, v7, v8
    v_cvt_pk_bf16_f32 v7, v7, v7
    v_lshlrev_b32 v7, 16, v7
    v_mul_f32 v8, s83, v84
    v_cvt_pk_bf16_f32 v8, v8, v8
    v_lshlrev_b32 v8, 16, v8
    v_add_f32 v7, v7, v8
    v_cvt_pk_bf16_f32 v7, v7, v7
    v_lshlrev_b32 v7, 16, v7
    v_mul_f32 v8, s82, v85
    v_cvt_pk_bf16_f32 v8, v8, v8
    v_lshlrev_b32 v8, 16, v8
    v_add_f32 v7, v7, v8
    v_cvt_pk_bf16_f32 v7, v7, v7
    v_lshlrev_b32 v7, 16, v7
    v_and_b32 v8, 0xffff0000, v47
    v_mul_f32 v7, v7, v8
    v_cvt_pk_bf16_f32 v156, v7, v7
    v_lshlrev_b32 v156, 16, v156
    v_mul_f32 v7, s85, v83
    v_cvt_pk_bf16_f32 v7, v7, v7
    v_lshlrev_b32 v7, 16, v7
    v_mul_f32 v8, s84, v84
    v_cvt_pk_bf16_f32 v8, v8, v8
    v_lshlrev_b32 v8, 16, v8
    v_add_f32 v7, v7, v8
    v_cvt_pk_bf16_f32 v7, v7, v7
    v_lshlrev_b32 v7, 16, v7
    v_mul_f32 v8, s83, v85
    v_cvt_pk_bf16_f32 v8, v8, v8
    v_lshlrev_b32 v8, 16, v8
    v_add_f32 v7, v7, v8
    v_cvt_pk_bf16_f32 v7, v7, v7
    v_lshlrev_b32 v7, 16, v7
    v_mul_f32 v8, s82, v86
    v_cvt_pk_bf16_f32 v8, v8, v8
    v_lshlrev_b32 v8, 16, v8
    v_add_f32 v7, v7, v8
    v_cvt_pk_bf16_f32 v7, v7, v7
    v_lshlrev_b32 v7, 16, v7
    v_and_b32 v8, 0xffff0000, v49
    v_mul_f32 v7, v7, v8
    v_cvt_pk_bf16_f32 v157, v7, v7
    v_lshlrev_b32 v157, 16, v157
    v_mul_f32 v7, s85, v84
    v_cvt_pk_bf16_f32 v7, v7, v7
    v_lshlrev_b32 v7, 16, v7
    v_mul_f32 v8, s84, v85
    v_cvt_pk_bf16_f32 v8, v8, v8
    v_lshlrev_b32 v8, 16, v8
    v_add_f32 v7, v7, v8
    v_cvt_pk_bf16_f32 v7, v7, v7
    v_lshlrev_b32 v7, 16, v7
    v_mul_f32 v8, s83, v86
    v_cvt_pk_bf16_f32 v8, v8, v8
    v_lshlrev_b32 v8, 16, v8
    v_add_f32 v7, v7, v8
    v_cvt_pk_bf16_f32 v7, v7, v7
    v_lshlrev_b32 v7, 16, v7
    v_mul_f32 v8, s82, v87
    v_cvt_pk_bf16_f32 v8, v8, v8
    v_lshlrev_b32 v8, 16, v8
    v_add_f32 v7, v7, v8
    v_cvt_pk_bf16_f32 v7, v7, v7
    v_lshlrev_b32 v7, 16, v7
    v_and_b32 v8, 0xffff0000, v51
    v_mul_f32 v7, v7, v8
    v_cvt_pk_bf16_f32 v158, v7, v7
    v_lshlrev_b32 v158, 16, v158
    v_mul_f32 v7, s85, v85
    v_cvt_pk_bf16_f32 v7, v7, v7
    v_lshlrev_b32 v7, 16, v7
    v_mul_f32 v8, s84, v86
    v_cvt_pk_bf16_f32 v8, v8, v8
    v_lshlrev_b32 v8, 16, v8
    v_add_f32 v7, v7, v8
    v_cvt_pk_bf16_f32 v7, v7, v7
    v_lshlrev_b32 v7, 16, v7
    v_mul_f32 v8, s83, v87
    v_cvt_pk_bf16_f32 v8, v8, v8
    v_lshlrev_b32 v8, 16, v8
    v_add_f32 v7, v7, v8
    v_cvt_pk_bf16_f32 v7, v7, v7
    v_lshlrev_b32 v7, 16, v7
    v_mul_f32 v8, s82, v88
    v_cvt_pk_bf16_f32 v8, v8, v8
    v_lshlrev_b32 v8, 16, v8
    v_add_f32 v7, v7, v8
    v_cvt_pk_bf16_f32 v7, v7, v7
    v_lshlrev_b32 v7, 16, v7
    v_and_b32 v8, 0xffff0000, v53
    v_mul_f32 v7, v7, v8
    v_cvt_pk_bf16_f32 v159, v7, v7
    v_lshlrev_b32 v159, 16, v159
    v_mul_f32 v7, s85, v86
    v_cvt_pk_bf16_f32 v7, v7, v7
    v_lshlrev_b32 v7, 16, v7
    v_mul_f32 v8, s84, v87
    v_cvt_pk_bf16_f32 v8, v8, v8
    v_lshlrev_b32 v8, 16, v8
    v_add_f32 v7, v7, v8
    v_cvt_pk_bf16_f32 v7, v7, v7
    v_lshlrev_b32 v7, 16, v7
    v_mul_f32 v8, s83, v88
    v_cvt_pk_bf16_f32 v8, v8, v8
    v_lshlrev_b32 v8, 16, v8
    v_add_f32 v7, v7, v8
    v_cvt_pk_bf16_f32 v7, v7, v7
    v_lshlrev_b32 v7, 16, v7
    v_mul_f32 v8, s82, v89
    v_cvt_pk_bf16_f32 v8, v8, v8
    v_lshlrev_b32 v8, 16, v8
    v_add_f32 v7, v7, v8
    v_cvt_pk_bf16_f32 v7, v7, v7
    v_lshlrev_b32 v7, 16, v7
    v_and_b32 v8, 0xffff0000, v55
    v_mul_f32 v7, v7, v8
    v_cvt_pk_bf16_f32 v160, v7, v7
    v_lshlrev_b32 v160, 16, v160
    v_mul_f32 v7, s85, v87
    v_cvt_pk_bf16_f32 v7, v7, v7
    v_lshlrev_b32 v7, 16, v7
    v_mul_f32 v8, s84, v88
    v_cvt_pk_bf16_f32 v8, v8, v8
    v_lshlrev_b32 v8, 16, v8
    v_add_f32 v7, v7, v8
    v_cvt_pk_bf16_f32 v7, v7, v7
    v_lshlrev_b32 v7, 16, v7
    v_mul_f32 v8, s83, v89
    v_cvt_pk_bf16_f32 v8, v8, v8
    v_lshlrev_b32 v8, 16, v8
    v_add_f32 v7, v7, v8
    v_cvt_pk_bf16_f32 v7, v7, v7
    v_lshlrev_b32 v7, 16, v7
    v_mul_f32 v8, s82, v90
    v_cvt_pk_bf16_f32 v8, v8, v8
    v_lshlrev_b32 v8, 16, v8
    v_add_f32 v7, v7, v8
    v_cvt_pk_bf16_f32 v7, v7, v7
    v_lshlrev_b32 v7, 16, v7
    v_and_b32 v8, 0xffff0000, v57
    v_mul_f32 v7, v7, v8
    v_cvt_pk_bf16_f32 v161, v7, v7
    v_lshlrev_b32 v161, 16, v161
    v_lshrrev_b32 v4, 2, v0
    v_mul_u32_u24 v4, 80, v4
    v_and_b32 v5, 3, v0
    v_lshl_add_u32 v4, v5, 4, v4
    v_lshrrev_b32 v92, 16, v130
    v_or_b32 v92, v92, v131
    v_lshrrev_b32 v93, 16, v132
    v_or_b32 v93, v93, v133
    v_lshrrev_b32 v94, 16, v134
    v_or_b32 v94, v94, v135
    v_lshrrev_b32 v95, 16, v136
    v_or_b32 v95, v95, v137
    ds_write_b128 v4, v[92:95] offset:33360
    s_nop 1
    v_lshrrev_b32 v92, 16, v138
    v_or_b32 v92, v92, v139
    v_lshrrev_b32 v93, 16, v140
    v_or_b32 v93, v93, v141
    v_lshrrev_b32 v94, 16, v142
    v_or_b32 v94, v94, v143
    v_lshrrev_b32 v95, 16, v144
    v_or_b32 v95, v95, v145
    v_add_u32 v5, 71840, v4
    ds_write_b128 v5, v[92:95]
    s_nop 1
    v_lshrrev_b32 v92, 16, v146
    v_or_b32 v92, v92, v147
    v_lshrrev_b32 v93, 16, v148
    v_or_b32 v93, v93, v149
    v_lshrrev_b32 v94, 16, v150
    v_or_b32 v94, v94, v151
    v_lshrrev_b32 v95, 16, v152
    v_or_b32 v95, v95, v153
    v_add_u32 v5, 110320, v4
    ds_write_b128 v5, v[92:95]
    s_nop 1
    v_lshrrev_b32 v92, 16, v154
    v_or_b32 v92, v92, v155
    v_lshrrev_b32 v93, 16, v156
    v_or_b32 v93, v93, v157
    v_lshrrev_b32 v94, 16, v158
    v_or_b32 v94, v94, v159
    v_lshrrev_b32 v95, 16, v160
    v_or_b32 v95, v95, v161
    v_add_u32 v5, 148800, v4
    ds_write_b128 v5, v[92:95]
    s_nop 1
    s_waitcnt vmcnt(0)
    s_mul_i32 s25, s22, 38480
    v_alignbit_b32 v170, v119, v119, 16
    v_alignbit_b32 v171, v118, v118, 16
    v_alignbit_b32 v172, v117, v117, 16
    v_alignbit_b32 v173, v116, v116, 16
    v_alignbit_b32 v174, v115, v115, 16
    v_alignbit_b32 v175, v114, v114, 16
    v_alignbit_b32 v176, v113, v113, 16
    v_alignbit_b32 v177, v112, v112, 16
    v_alignbit_b32 v178, v111, v111, 16
    v_alignbit_b32 v179, v110, v110, 16
    v_alignbit_b32 v180, v109, v109, 16
    v_alignbit_b32 v181, v108, v108, 16
    v_alignbit_b32 v182, v107, v107, 16
    v_alignbit_b32 v183, v106, v106, 16
    v_alignbit_b32 v184, v105, v105, 16
    v_alignbit_b32 v185, v104, v104, 16
    v_alignbit_b32 v186, v103, v103, 16
    v_alignbit_b32 v187, v102, v102, 16
    v_alignbit_b32 v188, v101, v101, 16
    v_alignbit_b32 v189, v100, v100, 16
    v_lshlrev_b32 v4, 6, v2
    v_add_u32 v4, s25, v4
    v_mov_b32 v192, v170
    v_mov_b32 v193, v171
    v_mov_b32 v194, v172
    v_mov_b32 v195, v173
    v_mov_b32 v196, v174
    v_mov_b32 v197, v175
    v_mov_b32 v198, v176
    v_mov_b32 v199, v177
    v_mov_b32 v200, v178
    v_mov_b32 v201, v179
    v_mov_b32 v202, v180
    v_mov_b32 v203, v181
    v_mov_b32 v204, v182
    v_mov_b32 v205, v183
    v_mov_b32 v206, v184
    v_mov_b32 v207, v185
    ds_write_b128 v4, v[192:195] offset:0
    ds_write_b128 v4, v[196:199] offset:16
    ds_write_b128 v4, v[200:203] offset:32
    ds_write_b128 v4, v[204:207] offset:48
    s_nop 1
    v_alignbit_b32 v192, v171, v170, 16
    v_alignbit_b32 v193, v172, v171, 16
    v_alignbit_b32 v194, v173, v172, 16
    v_alignbit_b32 v195, v174, v173, 16
    v_alignbit_b32 v196, v175, v174, 16
    v_alignbit_b32 v197, v176, v175, 16
    v_alignbit_b32 v198, v177, v176, 16
    v_alignbit_b32 v199, v178, v177, 16
    v_alignbit_b32 v200, v179, v178, 16
    v_alignbit_b32 v201, v180, v179, 16
    v_alignbit_b32 v202, v181, v180, 16
    v_alignbit_b32 v203, v182, v181, 16
    v_alignbit_b32 v204, v183, v182, 16
    v_alignbit_b32 v205, v184, v183, 16
    v_alignbit_b32 v206, v185, v184, 16
    v_alignbit_b32 v207, v186, v185, 16
    ds_write_b128 v4, v[192:195] offset:4160
    ds_write_b128 v4, v[196:199] offset:4176
    ds_write_b128 v4, v[200:203] offset:4192
    ds_write_b128 v4, v[204:207] offset:4208
    s_nop 1
    v_mov_b32 v192, v171
    v_mov_b32 v193, v172
    v_mov_b32 v194, v173
    v_mov_b32 v195, v174
    v_mov_b32 v196, v175
    v_mov_b32 v197, v176
    v_mov_b32 v198, v177
    v_mov_b32 v199, v178
    v_mov_b32 v200, v179
    v_mov_b32 v201, v180
    v_mov_b32 v202, v181
    v_mov_b32 v203, v182
    v_mov_b32 v204, v183
    v_mov_b32 v205, v184
    v_mov_b32 v206, v185
    v_mov_b32 v207, v186
    ds_write_b128 v4, v[192:195] offset:8320
    ds_write_b128 v4, v[196:199] offset:8336
    ds_write_b128 v4, v[200:203] offset:8352
    ds_write_b128 v4, v[204:207] offset:8368
    s_nop 1
    v_alignbit_b32 v192, v172, v171, 16
    v_alignbit_b32 v193, v173, v172, 16
    v_alignbit_b32 v194, v174, v173, 16
    v_alignbit_b32 v195, v175, v174, 16
    v_alignbit_b32 v196, v176, v175, 16
    v_alignbit_b32 v197, v177, v176, 16
    v_alignbit_b32 v198, v178, v177, 16
    v_alignbit_b32 v199, v179, v178, 16
    v_alignbit_b32 v200, v180, v179, 16
    v_alignbit_b32 v201, v181, v180, 16
    v_alignbit_b32 v202, v182, v181, 16
    v_alignbit_b32 v203, v183, v182, 16
    v_alignbit_b32 v204, v184, v183, 16
    v_alignbit_b32 v205, v185, v184, 16
    v_alignbit_b32 v206, v186, v185, 16
    v_alignbit_b32 v207, v187, v186, 16
    ds_write_b128 v4, v[192:195] offset:12480
    ds_write_b128 v4, v[196:199] offset:12496
    ds_write_b128 v4, v[200:203] offset:12512
    ds_write_b128 v4, v[204:207] offset:12528
    s_nop 1
    v_mov_b32 v192, v172
    v_mov_b32 v193, v173
    v_mov_b32 v194, v174
    v_mov_b32 v195, v175
    v_mov_b32 v196, v176
    v_mov_b32 v197, v177
    v_mov_b32 v198, v178
    v_mov_b32 v199, v179
    v_mov_b32 v200, v180
    v_mov_b32 v201, v181
    v_mov_b32 v202, v182
    v_mov_b32 v203, v183
    v_mov_b32 v204, v184
    v_mov_b32 v205, v185
    v_mov_b32 v206, v186
    v_mov_b32 v207, v187
    ds_write_b128 v4, v[192:195] offset:16640
    ds_write_b128 v4, v[196:199] offset:16656
    ds_write_b128 v4, v[200:203] offset:16672
    ds_write_b128 v4, v[204:207] offset:16688
    s_nop 1
    v_alignbit_b32 v192, v173, v172, 16
    v_alignbit_b32 v193, v174, v173, 16
    v_alignbit_b32 v194, v175, v174, 16
    v_alignbit_b32 v195, v176, v175, 16
    v_alignbit_b32 v196, v177, v176, 16
    v_alignbit_b32 v197, v178, v177, 16
    v_alignbit_b32 v198, v179, v178, 16
    v_alignbit_b32 v199, v180, v179, 16
    v_alignbit_b32 v200, v181, v180, 16
    v_alignbit_b32 v201, v182, v181, 16
    v_alignbit_b32 v202, v183, v182, 16
    v_alignbit_b32 v203, v184, v183, 16
    v_alignbit_b32 v204, v185, v184, 16
    v_alignbit_b32 v205, v186, v185, 16
    v_alignbit_b32 v206, v187, v186, 16
    v_alignbit_b32 v207, v188, v187, 16
    ds_write_b128 v4, v[192:195] offset:20800
    ds_write_b128 v4, v[196:199] offset:20816
    ds_write_b128 v4, v[200:203] offset:20832
    ds_write_b128 v4, v[204:207] offset:20848
    s_nop 1
    v_mov_b32 v192, v173
    v_mov_b32 v193, v174
    v_mov_b32 v194, v175
    v_mov_b32 v195, v176
    v_mov_b32 v196, v177
    v_mov_b32 v197, v178
    v_mov_b32 v198, v179
    v_mov_b32 v199, v180
    v_mov_b32 v200, v181
    v_mov_b32 v201, v182
    v_mov_b32 v202, v183
    v_mov_b32 v203, v184
    v_mov_b32 v204, v185
    v_mov_b32 v205, v186
    v_mov_b32 v206, v187
    v_mov_b32 v207, v188
    ds_write_b128 v4, v[192:195] offset:24960
    ds_write_b128 v4, v[196:199] offset:24976
    ds_write_b128 v4, v[200:203] offset:24992
    ds_write_b128 v4, v[204:207] offset:25008
    s_nop 1
    v_alignbit_b32 v192, v174, v173, 16
    v_alignbit_b32 v193, v175, v174, 16
    v_alignbit_b32 v194, v176, v175, 16
    v_alignbit_b32 v195, v177, v176, 16
    v_alignbit_b32 v196, v178, v177, 16
    v_alignbit_b32 v197, v179, v178, 16
    v_alignbit_b32 v198, v180, v179, 16
    v_alignbit_b32 v199, v181, v180, 16
    v_alignbit_b32 v200, v182, v181, 16
    v_alignbit_b32 v201, v183, v182, 16
    v_alignbit_b32 v202, v184, v183, 16
    v_alignbit_b32 v203, v185, v184, 16
    v_alignbit_b32 v204, v186, v185, 16
    v_alignbit_b32 v205, v187, v186, 16
    v_alignbit_b32 v206, v188, v187, 16
    v_alignbit_b32 v207, v189, v188, 16
    ds_write_b128 v4, v[192:195] offset:29120
    ds_write_b128 v4, v[196:199] offset:29136
    ds_write_b128 v4, v[200:203] offset:29152
    ds_write_b128 v4, v[204:207] offset:29168
    s_nop 1
    v_mov_b32 v192, 0
    v_mov_b32 v193, 0
    v_mov_b32 v194, 0
    v_mov_b32 v195, 0
    v_lshrrev_b32 v5, 2, v2
    v_mul_u32_u24 v5, 4160, v5
    v_and_b32 v6, 3, v2
    v_lshl_add_u32 v5, v6, 4, v5
    v_add_u32 v5, 4096, v5
    v_subrev_u32 v6, 32, v2
    v_lshlrev_b32 v6, 4, v6
    v_add_u32 v6, 33280, v6
    v_cmp_gt_u32 vcc, 32, v2
    s_nop 1
    v_cndmask_b32 v5, v6, v5, vcc
    v_add_u32 v5, s25, v5
    v_cmp_gt_u32 vcc, 37, v2
    s_and_saveexec_b64 s[92:93], vcc
    ds_write_b128 v5, v[192:195]
    s_mov_b64 exec, s[92:93]
    s_waitcnt lgkmcnt(0)
    s_barrier
    v_and_b32 v4, 31, v2
    v_lshrrev_b32 v5, 5, v2
    v_and_b32 v6, 7, v4
    v_sub_u32 v6, 7, v6
    v_mul_u32_u24 v7, 4160, v6
    v_lshrrev_b32 v8, 3, v4
    v_lshlrev_b32 v8, 4, v8
    v_sub_u32 v7, v7, v8
    v_lshl_add_u32 v7, v5, 4, v7
    v_add_u32 v7, 48, v7
    v_add_u32 v7, s25, v7
    s_add_u32 s26, s25, 33280
    v_lshlrev_b32 v9, 4, v5
    v_add_u32 v9, s26, v9
    v_mul_u32_u24 v10, 80, v4
    v_add_u32 v10, v10, v9
    v_add_u32 v10, 80, v10
    v_add_u32 v11, 2560, v10
    v_mov_b32 v208, 0
    v_mov_b32 v209, 0
    v_mov_b32 v210, 0
    v_mov_b32 v211, 0
    v_mov_b32 v212, 0
    v_mov_b32 v213, 0
    v_mov_b32 v214, 0
    v_mov_b32 v215, 0
    v_mov_b32 v216, 0
    v_mov_b32 v217, 0
    v_mov_b32 v218, 0
    v_mov_b32 v219, 0
    v_mov_b32 v220, 0
    v_mov_b32 v221, 0
    v_mov_b32 v222, 0
    v_mov_b32 v223, 0
    v_mov_b32 v224, 0
    v_mov_b32 v225, 0
    v_mov_b32 v226, 0
    v_mov_b32 v227, 0
    v_mov_b32 v228, 0
    v_mov_b32 v229, 0
    v_mov_b32 v230, 0
    v_mov_b32 v231, 0
    v_mov_b32 v232, 0
    v_mov_b32 v233, 0
    v_mov_b32 v234, 0
    v_mov_b32 v235, 0
    v_mov_b32 v236, 0
    v_mov_b32 v237, 0
    v_mov_b32 v238, 0
    v_mov_b32 v239, 0
    ds_read_b128 v[170:173], v7 offset:4032
    ds_read_b128 v[174:177], v7 offset:4064
    v_add_u32 v12, 0, v11
    v_max_i32 v12, v12, v9
    ds_read_b128 v[178:181], v12
    ds_read_b128 v[182:185], v12 offset:32
    v_add_u32 v13, 0, v10
    v_max_i32 v13, v13, v9
    ds_read_b128 v[186:189], v13
    ds_read_b128 v[190:193], v13 offset:32
    ds_read_b128 v[96:99], v7 offset:3968
    ds_read_b128 v[100:103], v7 offset:4000
    v_add_u32 v12, 4294967216, v11
    v_max_i32 v12, v12, v9
    ds_read_b128 v[104:107], v12
    ds_read_b128 v[108:111], v12 offset:32
    v_add_u32 v13, 4294967216, v10
    v_max_i32 v13, v13, v9
    ds_read_b128 v[112:115], v13
    ds_read_b128 v[116:119], v13 offset:32
    s_waitcnt lgkmcnt(6)
    v_mfma_f32_32x32x16_bf16 v[224:239], v[170:173], v[178:181], v[224:239]
    v_mfma_f32_32x32x16_bf16 v[208:223], v[170:173], v[186:189], v[208:223]
    v_mfma_f32_32x32x16_bf16 v[224:239], v[174:177], v[182:185], v[224:239]
    v_mfma_f32_32x32x16_bf16 v[208:223], v[174:177], v[190:193], v[208:223]
    ds_read_b128 v[170:173], v7 offset:3904
    ds_read_b128 v[174:177], v7 offset:3936
    v_add_u32 v12, 4294967136, v11
    v_max_i32 v12, v12, v9
    ds_read_b128 v[178:181], v12
    ds_read_b128 v[182:185], v12 offset:32
    v_add_u32 v13, 4294967136, v10
    v_max_i32 v13, v13, v9
    ds_read_b128 v[186:189], v13
    ds_read_b128 v[190:193], v13 offset:32
    s_waitcnt lgkmcnt(6)
    v_mfma_f32_32x32x16_bf16 v[224:239], v[96:99], v[104:107], v[224:239]
    v_mfma_f32_32x32x16_bf16 v[208:223], v[96:99], v[112:115], v[208:223]
    v_mfma_f32_32x32x16_bf16 v[224:239], v[100:103], v[108:111], v[224:239]
    v_mfma_f32_32x32x16_bf16 v[208:223], v[100:103], v[116:119], v[208:223]
    ds_read_b128 v[96:99], v7 offset:3840
    ds_read_b128 v[100:103], v7 offset:3872
    v_add_u32 v12, 4294967056, v11
    v_max_i32 v12, v12, v9
    ds_read_b128 v[104:107], v12
    ds_read_b128 v[108:111], v12 offset:32
    v_add_u32 v13, 4294967056, v10
    v_max_i32 v13, v13, v9
    ds_read_b128 v[112:115], v13
    ds_read_b128 v[116:119], v13 offset:32
    s_waitcnt lgkmcnt(6)
    v_mfma_f32_32x32x16_bf16 v[224:239], v[170:173], v[178:181], v[224:239]
    v_mfma_f32_32x32x16_bf16 v[208:223], v[170:173], v[186:189], v[208:223]
    v_mfma_f32_32x32x16_bf16 v[224:239], v[174:177], v[182:185], v[224:239]
    v_mfma_f32_32x32x16_bf16 v[208:223], v[174:177], v[190:193], v[208:223]
    ds_read_b128 v[170:173], v7 offset:3776
    ds_read_b128 v[174:177], v7 offset:3808
    v_add_u32 v12, 4294966976, v11
    v_max_i32 v12, v12, v9
    ds_read_b128 v[178:181], v12
    ds_read_b128 v[182:185], v12 offset:32
    v_add_u32 v13, 4294966976, v10
    v_max_i32 v13, v13, v9
    ds_read_b128 v[186:189], v13
    ds_read_b128 v[190:193], v13 offset:32
    s_waitcnt lgkmcnt(6)
    v_mfma_f32_32x32x16_bf16 v[224:239], v[96:99], v[104:107], v[224:239]
    v_mfma_f32_32x32x16_bf16 v[208:223], v[96:99], v[112:115], v[208:223]
    v_mfma_f32_32x32x16_bf16 v[224:239], v[100:103], v[108:111], v[224:239]
    v_mfma_f32_32x32x16_bf16 v[208:223], v[100:103], v[116:119], v[208:223]
    ds_read_b128 v[96:99], v7 offset:3712
    ds_read_b128 v[100:103], v7 offset:3744
    v_add_u32 v12, 4294966896, v11
    v_max_i32 v12, v12, v9
    ds_read_b128 v[104:107], v12
    ds_read_b128 v[108:111], v12 offset:32
    v_add_u32 v13, 4294966896, v10
    v_max_i32 v13, v13, v9
    ds_read_b128 v[112:115], v13
    ds_read_b128 v[116:119], v13 offset:32
    s_waitcnt lgkmcnt(6)
    v_mfma_f32_32x32x16_bf16 v[224:239], v[170:173], v[178:181], v[224:239]
    v_mfma_f32_32x32x16_bf16 v[208:223], v[170:173], v[186:189], v[208:223]
    v_mfma_f32_32x32x16_bf16 v[224:239], v[174:177], v[182:185], v[224:239]
    v_mfma_f32_32x32x16_bf16 v[208:223], v[174:177], v[190:193], v[208:223]
    ds_read_b128 v[170:173], v7 offset:3648
    ds_read_b128 v[174:177], v7 offset:3680
    v_add_u32 v12, 4294966816, v11
    v_max_i32 v12, v12, v9
    ds_read_b128 v[178:181], v12
    ds_read_b128 v[182:185], v12 offset:32
    v_add_u32 v13, 4294966816, v10
    v_max_i32 v13, v13, v9
    ds_read_b128 v[186:189], v13
    ds_read_b128 v[190:193], v13 offset:32
    s_waitcnt lgkmcnt(6)
    v_mfma_f32_32x32x16_bf16 v[224:239], v[96:99], v[104:107], v[224:239]
    v_mfma_f32_32x32x16_bf16 v[208:223], v[96:99], v[112:115], v[208:223]
    v_mfma_f32_32x32x16_bf16 v[224:239], v[100:103], v[108:111], v[224:239]
    v_mfma_f32_32x32x16_bf16 v[208:223], v[100:103], v[116:119], v[208:223]
    ds_read_b128 v[96:99], v7 offset:3584
    ds_read_b128 v[100:103], v7 offset:3616
    v_add_u32 v12, 4294966736, v11
    v_max_i32 v12, v12, v9
    ds_read_b128 v[104:107], v12
    ds_read_b128 v[108:111], v12 offset:32
    v_add_u32 v13, 4294966736, v10
    v_max_i32 v13, v13, v9
    ds_read_b128 v[112:115], v13
    ds_read_b128 v[116:119], v13 offset:32
    s_waitcnt lgkmcnt(6)
    v_mfma_f32_32x32x16_bf16 v[224:239], v[170:173], v[178:181], v[224:239]
    v_mfma_f32_32x32x16_bf16 v[208:223], v[170:173], v[186:189], v[208:223]
    v_mfma_f32_32x32x16_bf16 v[224:239], v[174:177], v[182:185], v[224:239]
    v_mfma_f32_32x32x16_bf16 v[208:223], v[174:177], v[190:193], v[208:223]
    ds_read_b128 v[170:173], v7 offset:3520
    ds_read_b128 v[174:177], v7 offset:3552
    v_add_u32 v12, 4294966656, v11
    v_max_i32 v12, v12, v9
    ds_read_b128 v[178:181], v12
    ds_read_b128 v[182:185], v12 offset:32
    v_add_u32 v13, 4294966656, v10
    v_max_i32 v13, v13, v9
    ds_read_b128 v[186:189], v13
    ds_read_b128 v[190:193], v13 offset:32
    s_waitcnt lgkmcnt(6)
    v_mfma_f32_32x32x16_bf16 v[224:239], v[96:99], v[104:107], v[224:239]
    v_mfma_f32_32x32x16_bf16 v[208:223], v[96:99], v[112:115], v[208:223]
    v_mfma_f32_32x32x16_bf16 v[224:239], v[100:103], v[108:111], v[224:239]
    v_mfma_f32_32x32x16_bf16 v[208:223], v[100:103], v[116:119], v[208:223]
    ds_read_b128 v[96:99], v7 offset:3456
    ds_read_b128 v[100:103], v7 offset:3488
    v_add_u32 v12, 4294966576, v11
    v_max_i32 v12, v12, v9
    ds_read_b128 v[104:107], v12
    ds_read_b128 v[108:111], v12 offset:32
    v_add_u32 v13, 4294966576, v10
    v_max_i32 v13, v13, v9
    ds_read_b128 v[112:115], v13
    ds_read_b128 v[116:119], v13 offset:32
    s_waitcnt lgkmcnt(6)
    v_mfma_f32_32x32x16_bf16 v[224:239], v[170:173], v[178:181], v[224:239]
    v_mfma_f32_32x32x16_bf16 v[208:223], v[170:173], v[186:189], v[208:223]
    v_mfma_f32_32x32x16_bf16 v[224:239], v[174:177], v[182:185], v[224:239]
    v_mfma_f32_32x32x16_bf16 v[208:223], v[174:177], v[190:193], v[208:223]
    ds_read_b128 v[170:173], v7 offset:3392
    ds_read_b128 v[174:177], v7 offset:3424
    v_add_u32 v12, 4294966496, v11
    v_max_i32 v12, v12, v9
    ds_read_b128 v[178:181], v12
    ds_read_b128 v[182:185], v12 offset:32
    v_add_u32 v13, 4294966496, v10
    v_max_i32 v13, v13, v9
    ds_read_b128 v[186:189], v13
    ds_read_b128 v[190:193], v13 offset:32
    s_waitcnt lgkmcnt(6)
    v_mfma_f32_32x32x16_bf16 v[224:239], v[96:99], v[104:107], v[224:239]
    v_mfma_f32_32x32x16_bf16 v[208:223], v[96:99], v[112:115], v[208:223]
    v_mfma_f32_32x32x16_bf16 v[224:239], v[100:103], v[108:111], v[224:239]
    v_mfma_f32_32x32x16_bf16 v[208:223], v[100:103], v[116:119], v[208:223]
    ds_read_b128 v[96:99], v7 offset:3328
    ds_read_b128 v[100:103], v7 offset:3360
    v_add_u32 v12, 4294966416, v11
    v_max_i32 v12, v12, v9
    ds_read_b128 v[104:107], v12
    ds_read_b128 v[108:111], v12 offset:32
    v_add_u32 v13, 4294966416, v10
    v_max_i32 v13, v13, v9
    ds_read_b128 v[112:115], v13
    ds_read_b128 v[116:119], v13 offset:32
    s_waitcnt lgkmcnt(6)
    v_mfma_f32_32x32x16_bf16 v[224:239], v[170:173], v[178:181], v[224:239]
    v_mfma_f32_32x32x16_bf16 v[208:223], v[170:173], v[186:189], v[208:223]
    v_mfma_f32_32x32x16_bf16 v[224:239], v[174:177], v[182:185], v[224:239]
    v_mfma_f32_32x32x16_bf16 v[208:223], v[174:177], v[190:193], v[208:223]
    ds_read_b128 v[170:173], v7 offset:3264
    ds_read_b128 v[174:177], v7 offset:3296
    v_add_u32 v12, 4294966336, v11
    v_max_i32 v12, v12, v9
    ds_read_b128 v[178:181], v12
    ds_read_b128 v[182:185], v12 offset:32
    v_add_u32 v13, 4294966336, v10
    v_max_i32 v13, v13, v9
    ds_read_b128 v[186:189], v13
    ds_read_b128 v[190:193], v13 offset:32
    s_waitcnt lgkmcnt(6)
    v_mfma_f32_32x32x16_bf16 v[224:239], v[96:99], v[104:107], v[224:239]
    v_mfma_f32_32x32x16_bf16 v[208:223], v[96:99], v[112:115], v[208:223]
    v_mfma_f32_32x32x16_bf16 v[224:239], v[100:103], v[108:111], v[224:239]
    v_mfma_f32_32x32x16_bf16 v[208:223], v[100:103], v[116:119], v[208:223]
    ds_read_b128 v[96:99], v7 offset:3200
    ds_read_b128 v[100:103], v7 offset:3232
    v_add_u32 v12, 4294966256, v11
    v_max_i32 v12, v12, v9
    ds_read_b128 v[104:107], v12
    ds_read_b128 v[108:111], v12 offset:32
    v_add_u32 v13, 4294966256, v10
    v_max_i32 v13, v13, v9
    ds_read_b128 v[112:115], v13
    ds_read_b128 v[116:119], v13 offset:32
    s_waitcnt lgkmcnt(6)
    v_mfma_f32_32x32x16_bf16 v[224:239], v[170:173], v[178:181], v[224:239]
    v_mfma_f32_32x32x16_bf16 v[208:223], v[170:173], v[186:189], v[208:223]
    v_mfma_f32_32x32x16_bf16 v[224:239], v[174:177], v[182:185], v[224:239]
    v_mfma_f32_32x32x16_bf16 v[208:223], v[174:177], v[190:193], v[208:223]
    ds_read_b128 v[170:173], v7 offset:3136
    ds_read_b128 v[174:177], v7 offset:3168
    v_add_u32 v12, 4294966176, v11
    v_max_i32 v12, v12, v9
    ds_read_b128 v[178:181], v12
    ds_read_b128 v[182:185], v12 offset:32
    v_add_u32 v13, 4294966176, v10
    v_max_i32 v13, v13, v9
    ds_read_b128 v[186:189], v13
    ds_read_b128 v[190:193], v13 offset:32
    s_waitcnt lgkmcnt(6)
    v_mfma_f32_32x32x16_bf16 v[224:239], v[96:99], v[104:107], v[224:239]
    v_mfma_f32_32x32x16_bf16 v[208:223], v[96:99], v[112:115], v[208:223]
    v_mfma_f32_32x32x16_bf16 v[224:239], v[100:103], v[108:111], v[224:239]
    v_mfma_f32_32x32x16_bf16 v[208:223], v[100:103], v[116:119], v[208:223]
    ds_read_b128 v[96:99], v7 offset:3072
    ds_read_b128 v[100:103], v7 offset:3104
    v_add_u32 v12, 4294966096, v11
    v_max_i32 v12, v12, v9
    ds_read_b128 v[104:107], v12
    ds_read_b128 v[108:111], v12 offset:32
    v_add_u32 v13, 4294966096, v10
    v_max_i32 v13, v13, v9
    ds_read_b128 v[112:115], v13
    ds_read_b128 v[116:119], v13 offset:32
    s_waitcnt lgkmcnt(6)
    v_mfma_f32_32x32x16_bf16 v[224:239], v[170:173], v[178:181], v[224:239]
    v_mfma_f32_32x32x16_bf16 v[208:223], v[170:173], v[186:189], v[208:223]
    v_mfma_f32_32x32x16_bf16 v[224:239], v[174:177], v[182:185], v[224:239]
    v_mfma_f32_32x32x16_bf16 v[208:223], v[174:177], v[190:193], v[208:223]
    ds_read_b128 v[170:173], v7 offset:3008
    ds_read_b128 v[174:177], v7 offset:3040
    v_add_u32 v12, 4294966016, v11
    v_max_i32 v12, v12, v9
    ds_read_b128 v[178:181], v12
    ds_read_b128 v[182:185], v12 offset:32
    v_add_u32 v13, 4294966016, v10
    v_max_i32 v13, v13, v9
    ds_read_b128 v[186:189], v13
    ds_read_b128 v[190:193], v13 offset:32
    s_waitcnt lgkmcnt(6)
    v_mfma_f32_32x32x16_bf16 v[224:239], v[96:99], v[104:107], v[224:239]
    v_mfma_f32_32x32x16_bf16 v[208:223], v[96:99], v[112:115], v[208:223]
    v_mfma_f32_32x32x16_bf16 v[224:239], v[100:103], v[108:111], v[224:239]
    v_mfma_f32_32x32x16_bf16 v[208:223], v[100:103], v[116:119], v[208:223]
    ds_read_b128 v[96:99], v7 offset:2944
    ds_read_b128 v[100:103], v7 offset:2976
    v_add_u32 v12, 4294965936, v11
    v_max_i32 v12, v12, v9
    ds_read_b128 v[104:107], v12
    ds_read_b128 v[108:111], v12 offset:32
    v_add_u32 v13, 4294965936, v10
    v_max_i32 v13, v13, v9
    ds_read_b128 v[112:115], v13
    ds_read_b128 v[116:119], v13 offset:32
    s_waitcnt lgkmcnt(6)
    v_mfma_f32_32x32x16_bf16 v[224:239], v[170:173], v[178:181], v[224:239]
    v_mfma_f32_32x32x16_bf16 v[208:223], v[170:173], v[186:189], v[208:223]
    v_mfma_f32_32x32x16_bf16 v[224:239], v[174:177], v[182:185], v[224:239]
    v_mfma_f32_32x32x16_bf16 v[208:223], v[174:177], v[190:193], v[208:223]
    ds_read_b128 v[170:173], v7 offset:2880
    ds_read_b128 v[174:177], v7 offset:2912
    v_add_u32 v12, 4294965856, v11
    v_max_i32 v12, v12, v9
    ds_read_b128 v[178:181], v12
    ds_read_b128 v[182:185], v12 offset:32
    v_add_u32 v13, 4294965856, v10
    v_max_i32 v13, v13, v9
    ds_read_b128 v[186:189], v13
    ds_read_b128 v[190:193], v13 offset:32
    s_waitcnt lgkmcnt(6)
    v_mfma_f32_32x32x16_bf16 v[224:239], v[96:99], v[104:107], v[224:239]
    v_mfma_f32_32x32x16_bf16 v[208:223], v[96:99], v[112:115], v[208:223]
    v_mfma_f32_32x32x16_bf16 v[224:239], v[100:103], v[108:111], v[224:239]
    v_mfma_f32_32x32x16_bf16 v[208:223], v[100:103], v[116:119], v[208:223]
    ds_read_b128 v[96:99], v7 offset:2816
    ds_read_b128 v[100:103], v7 offset:2848
    v_add_u32 v12, 4294965776, v11
    v_max_i32 v12, v12, v9
    ds_read_b128 v[104:107], v12
    ds_read_b128 v[108:111], v12 offset:32
    v_add_u32 v13, 4294965776, v10
    v_max_i32 v13, v13, v9
    ds_read_b128 v[112:115], v13
    ds_read_b128 v[116:119], v13 offset:32
    s_waitcnt lgkmcnt(6)
    v_mfma_f32_32x32x16_bf16 v[224:239], v[170:173], v[178:181], v[224:239]
    v_mfma_f32_32x32x16_bf16 v[208:223], v[170:173], v[186:189], v[208:223]
    v_mfma_f32_32x32x16_bf16 v[224:239], v[174:177], v[182:185], v[224:239]
    v_mfma_f32_32x32x16_bf16 v[208:223], v[174:177], v[190:193], v[208:223]
    ds_read_b128 v[170:173], v7 offset:2752
    ds_read_b128 v[174:177], v7 offset:2784
    v_add_u32 v12, 4294965696, v11
    v_max_i32 v12, v12, v9
    ds_read_b128 v[178:181], v12
    ds_read_b128 v[182:185], v12 offset:32
    v_add_u32 v13, 4294965696, v10
    v_max_i32 v13, v13, v9
    ds_read_b128 v[186:189], v13
    ds_read_b128 v[190:193], v13 offset:32
    s_waitcnt lgkmcnt(6)
    v_mfma_f32_32x32x16_bf16 v[224:239], v[96:99], v[104:107], v[224:239]
    v_mfma_f32_32x32x16_bf16 v[208:223], v[96:99], v[112:115], v[208:223]
    v_mfma_f32_32x32x16_bf16 v[224:239], v[100:103], v[108:111], v[224:239]
    v_mfma_f32_32x32x16_bf16 v[208:223], v[100:103], v[116:119], v[208:223]
    ds_read_b128 v[96:99], v7 offset:2688
    ds_read_b128 v[100:103], v7 offset:2720
    v_add_u32 v12, 4294965616, v11
    v_max_i32 v12, v12, v9
    ds_read_b128 v[104:107], v12
    ds_read_b128 v[108:111], v12 offset:32
    v_add_u32 v13, 4294965616, v10
    v_max_i32 v13, v13, v9
    ds_read_b128 v[112:115], v13
    ds_read_b128 v[116:119], v13 offset:32
    s_waitcnt lgkmcnt(6)
    v_mfma_f32_32x32x16_bf16 v[224:239], v[170:173], v[178:181], v[224:239]
    v_mfma_f32_32x32x16_bf16 v[208:223], v[170:173], v[186:189], v[208:223]
    v_mfma_f32_32x32x16_bf16 v[224:239], v[174:177], v[182:185], v[224:239]
    v_mfma_f32_32x32x16_bf16 v[208:223], v[174:177], v[190:193], v[208:223]
    ds_read_b128 v[170:173], v7 offset:2624
    ds_read_b128 v[174:177], v7 offset:2656
    v_add_u32 v12, 4294965536, v11
    v_max_i32 v12, v12, v9
    ds_read_b128 v[178:181], v12
    ds_read_b128 v[182:185], v12 offset:32
    v_add_u32 v13, 4294965536, v10
    v_max_i32 v13, v13, v9
    ds_read_b128 v[186:189], v13
    ds_read_b128 v[190:193], v13 offset:32
    s_waitcnt lgkmcnt(6)
    v_mfma_f32_32x32x16_bf16 v[224:239], v[96:99], v[104:107], v[224:239]
    v_mfma_f32_32x32x16_bf16 v[208:223], v[96:99], v[112:115], v[208:223]
    v_mfma_f32_32x32x16_bf16 v[224:239], v[100:103], v[108:111], v[224:239]
    v_mfma_f32_32x32x16_bf16 v[208:223], v[100:103], v[116:119], v[208:223]
    ds_read_b128 v[96:99], v7 offset:2560
    ds_read_b128 v[100:103], v7 offset:2592
    v_add_u32 v12, 4294965456, v11
    v_max_i32 v12, v12, v9
    ds_read_b128 v[104:107], v12
    ds_read_b128 v[108:111], v12 offset:32
    v_add_u32 v13, 4294965456, v10
    v_max_i32 v13, v13, v9
    ds_read_b128 v[112:115], v13
    ds_read_b128 v[116:119], v13 offset:32
    s_waitcnt lgkmcnt(6)
    v_mfma_f32_32x32x16_bf16 v[224:239], v[170:173], v[178:181], v[224:239]
    v_mfma_f32_32x32x16_bf16 v[208:223], v[170:173], v[186:189], v[208:223]
    v_mfma_f32_32x32x16_bf16 v[224:239], v[174:177], v[182:185], v[224:239]
    v_mfma_f32_32x32x16_bf16 v[208:223], v[174:177], v[190:193], v[208:223]
    ds_read_b128 v[170:173], v7 offset:2496
    ds_read_b128 v[174:177], v7 offset:2528
    v_add_u32 v12, 4294965376, v11
    v_max_i32 v12, v12, v9
    ds_read_b128 v[178:181], v12
    ds_read_b128 v[182:185], v12 offset:32
    v_add_u32 v13, 4294965376, v10
    v_max_i32 v13, v13, v9
    ds_read_b128 v[186:189], v13
    ds_read_b128 v[190:193], v13 offset:32
    s_waitcnt lgkmcnt(6)
    v_mfma_f32_32x32x16_bf16 v[224:239], v[96:99], v[104:107], v[224:239]
    v_mfma_f32_32x32x16_bf16 v[208:223], v[96:99], v[112:115], v[208:223]
    v_mfma_f32_32x32x16_bf16 v[224:239], v[100:103], v[108:111], v[224:239]
    v_mfma_f32_32x32x16_bf16 v[208:223], v[100:103], v[116:119], v[208:223]
    ds_read_b128 v[96:99], v7 offset:2432
    ds_read_b128 v[100:103], v7 offset:2464
    v_add_u32 v12, 4294965296, v11
    v_max_i32 v12, v12, v9
    ds_read_b128 v[104:107], v12
    ds_read_b128 v[108:111], v12 offset:32
    v_add_u32 v13, 4294965296, v10
    v_max_i32 v13, v13, v9
    ds_read_b128 v[112:115], v13
    ds_read_b128 v[116:119], v13 offset:32
    s_waitcnt lgkmcnt(6)
    v_mfma_f32_32x32x16_bf16 v[224:239], v[170:173], v[178:181], v[224:239]
    v_mfma_f32_32x32x16_bf16 v[208:223], v[170:173], v[186:189], v[208:223]
    v_mfma_f32_32x32x16_bf16 v[224:239], v[174:177], v[182:185], v[224:239]
    v_mfma_f32_32x32x16_bf16 v[208:223], v[174:177], v[190:193], v[208:223]
    ds_read_b128 v[170:173], v7 offset:2368
    ds_read_b128 v[174:177], v7 offset:2400
    v_add_u32 v12, 4294965216, v11
    v_max_i32 v12, v12, v9
    ds_read_b128 v[178:181], v12
    ds_read_b128 v[182:185], v12 offset:32
    v_add_u32 v13, 4294965216, v10
    v_max_i32 v13, v13, v9
    ds_read_b128 v[186:189], v13
    ds_read_b128 v[190:193], v13 offset:32
    s_waitcnt lgkmcnt(6)
    v_mfma_f32_32x32x16_bf16 v[224:239], v[96:99], v[104:107], v[224:239]
    v_mfma_f32_32x32x16_bf16 v[208:223], v[96:99], v[112:115], v[208:223]
    v_mfma_f32_32x32x16_bf16 v[224:239], v[100:103], v[108:111], v[224:239]
    v_mfma_f32_32x32x16_bf16 v[208:223], v[100:103], v[116:119], v[208:223]
    ds_read_b128 v[96:99], v7 offset:2304
    ds_read_b128 v[100:103], v7 offset:2336
    v_add_u32 v12, 4294965136, v11
    v_max_i32 v12, v12, v9
    ds_read_b128 v[104:107], v12
    ds_read_b128 v[108:111], v12 offset:32
    v_add_u32 v13, 4294965136, v10
    v_max_i32 v13, v13, v9
    ds_read_b128 v[112:115], v13
    ds_read_b128 v[116:119], v13 offset:32
    s_waitcnt lgkmcnt(6)
    v_mfma_f32_32x32x16_bf16 v[224:239], v[170:173], v[178:181], v[224:239]
    v_mfma_f32_32x32x16_bf16 v[208:223], v[170:173], v[186:189], v[208:223]
    v_mfma_f32_32x32x16_bf16 v[224:239], v[174:177], v[182:185], v[224:239]
    v_mfma_f32_32x32x16_bf16 v[208:223], v[174:177], v[190:193], v[208:223]
    ds_read_b128 v[170:173], v7 offset:2240
    ds_read_b128 v[174:177], v7 offset:2272
    v_add_u32 v12, 4294965056, v11
    v_max_i32 v12, v12, v9
    ds_read_b128 v[178:181], v12
    ds_read_b128 v[182:185], v12 offset:32
    v_add_u32 v13, 4294965056, v10
    v_max_i32 v13, v13, v9
    ds_read_b128 v[186:189], v13
    ds_read_b128 v[190:193], v13 offset:32
    s_waitcnt lgkmcnt(6)
    v_mfma_f32_32x32x16_bf16 v[224:239], v[96:99], v[104:107], v[224:239]
    v_mfma_f32_32x32x16_bf16 v[208:223], v[96:99], v[112:115], v[208:223]
    v_mfma_f32_32x32x16_bf16 v[224:239], v[100:103], v[108:111], v[224:239]
    v_mfma_f32_32x32x16_bf16 v[208:223], v[100:103], v[116:119], v[208:223]
    ds_read_b128 v[96:99], v7 offset:2176
    ds_read_b128 v[100:103], v7 offset:2208
    v_add_u32 v12, 4294964976, v11
    v_max_i32 v12, v12, v9
    ds_read_b128 v[104:107], v12
    ds_read_b128 v[108:111], v12 offset:32
    v_add_u32 v13, 4294964976, v10
    v_max_i32 v13, v13, v9
    ds_read_b128 v[112:115], v13
    ds_read_b128 v[116:119], v13 offset:32
    s_waitcnt lgkmcnt(6)
    v_mfma_f32_32x32x16_bf16 v[224:239], v[170:173], v[178:181], v[224:239]
    v_mfma_f32_32x32x16_bf16 v[208:223], v[170:173], v[186:189], v[208:223]
    v_mfma_f32_32x32x16_bf16 v[224:239], v[174:177], v[182:185], v[224:239]
    v_mfma_f32_32x32x16_bf16 v[208:223], v[174:177], v[190:193], v[208:223]
    ds_read_b128 v[170:173], v7 offset:2112
    ds_read_b128 v[174:177], v7 offset:2144
    v_add_u32 v12, 4294964896, v11
    v_max_i32 v12, v12, v9
    ds_read_b128 v[178:181], v12
    ds_read_b128 v[182:185], v12 offset:32
    v_add_u32 v13, 4294964896, v10
    v_max_i32 v13, v13, v9
    ds_read_b128 v[186:189], v13
    ds_read_b128 v[190:193], v13 offset:32
    s_waitcnt lgkmcnt(6)
    v_mfma_f32_32x32x16_bf16 v[224:239], v[96:99], v[104:107], v[224:239]
    v_mfma_f32_32x32x16_bf16 v[208:223], v[96:99], v[112:115], v[208:223]
    v_mfma_f32_32x32x16_bf16 v[224:239], v[100:103], v[108:111], v[224:239]
    v_mfma_f32_32x32x16_bf16 v[208:223], v[100:103], v[116:119], v[208:223]
    ds_read_b128 v[96:99], v7 offset:2048
    ds_read_b128 v[100:103], v7 offset:2080
    v_add_u32 v12, 4294964816, v11
    v_max_i32 v12, v12, v9
    ds_read_b128 v[104:107], v12
    ds_read_b128 v[108:111], v12 offset:32
    v_add_u32 v13, 4294964816, v10
    v_max_i32 v13, v13, v9
    ds_read_b128 v[112:115], v13
    ds_read_b128 v[116:119], v13 offset:32
    s_waitcnt lgkmcnt(6)
    v_mfma_f32_32x32x16_bf16 v[224:239], v[170:173], v[178:181], v[224:239]
    v_mfma_f32_32x32x16_bf16 v[208:223], v[170:173], v[186:189], v[208:223]
    v_mfma_f32_32x32x16_bf16 v[224:239], v[174:177], v[182:185], v[224:239]
    v_mfma_f32_32x32x16_bf16 v[208:223], v[174:177], v[190:193], v[208:223]
    ds_read_b128 v[170:173], v7 offset:1984
    ds_read_b128 v[174:177], v7 offset:2016
    v_add_u32 v12, 4294964736, v11
    v_max_i32 v12, v12, v9
    ds_read_b128 v[178:181], v12
    ds_read_b128 v[182:185], v12 offset:32
    s_waitcnt lgkmcnt(4)
    v_mfma_f32_32x32x16_bf16 v[224:239], v[96:99], v[104:107], v[224:239]
    v_mfma_f32_32x32x16_bf16 v[208:223], v[96:99], v[112:115], v[208:223]
    v_mfma_f32_32x32x16_bf16 v[224:239], v[100:103], v[108:111], v[224:239]
    v_mfma_f32_32x32x16_bf16 v[208:223], v[100:103], v[116:119], v[208:223]
    ds_read_b128 v[96:99], v7 offset:1920
    ds_read_b128 v[100:103], v7 offset:1952
    v_add_u32 v12, 4294964656, v11
    v_max_i32 v12, v12, v9
    ds_read_b128 v[104:107], v12
    ds_read_b128 v[108:111], v12 offset:32
    s_waitcnt lgkmcnt(4)
    v_mfma_f32_32x32x16_bf16 v[224:239], v[170:173], v[178:181], v[224:239]
    v_mfma_f32_32x32x16_bf16 v[224:239], v[174:177], v[182:185], v[224:239]
    ds_read_b128 v[170:173], v7 offset:1856
    ds_read_b128 v[174:177], v7 offset:1888
    v_add_u32 v12, 4294964576, v11
    v_max_i32 v12, v12, v9
    ds_read_b128 v[178:181], v12
    ds_read_b128 v[182:185], v12 offset:32
    s_waitcnt lgkmcnt(4)
    v_mfma_f32_32x32x16_bf16 v[224:239], v[96:99], v[104:107], v[224:239]
    v_mfma_f32_32x32x16_bf16 v[224:239], v[100:103], v[108:111], v[224:239]
    ds_read_b128 v[96:99], v7 offset:1792
    ds_read_b128 v[100:103], v7 offset:1824
    v_add_u32 v12, 4294964496, v11
    v_max_i32 v12, v12, v9
    ds_read_b128 v[104:107], v12
    ds_read_b128 v[108:111], v12 offset:32
    s_waitcnt lgkmcnt(4)
    v_mfma_f32_32x32x16_bf16 v[224:239], v[170:173], v[178:181], v[224:239]
    v_mfma_f32_32x32x16_bf16 v[224:239], v[174:177], v[182:185], v[224:239]
    ds_read_b128 v[170:173], v7 offset:1728
    ds_read_b128 v[174:177], v7 offset:1760
    v_add_u32 v12, 4294964416, v11
    v_max_i32 v12, v12, v9
    ds_read_b128 v[178:181], v12
    ds_read_b128 v[182:185], v12 offset:32
    s_waitcnt lgkmcnt(4)
    v_mfma_f32_32x32x16_bf16 v[224:239], v[96:99], v[104:107], v[224:239]
    v_mfma_f32_32x32x16_bf16 v[224:239], v[100:103], v[108:111], v[224:239]
    ds_read_b128 v[96:99], v7 offset:1664
    ds_read_b128 v[100:103], v7 offset:1696
    v_add_u32 v12, 4294964336, v11
    v_max_i32 v12, v12, v9
    ds_read_b128 v[104:107], v12
    ds_read_b128 v[108:111], v12 offset:32
    s_waitcnt lgkmcnt(4)
    v_mfma_f32_32x32x16_bf16 v[224:239], v[170:173], v[178:181], v[224:239]
    v_mfma_f32_32x32x16_bf16 v[224:239], v[174:177], v[182:185], v[224:239]
    ds_read_b128 v[170:173], v7 offset:1600
    ds_read_b128 v[174:177], v7 offset:1632
    v_add_u32 v12, 4294964256, v11
    v_max_i32 v12, v12, v9
    ds_read_b128 v[178:181], v12
    ds_read_b128 v[182:185], v12 offset:32
    s_waitcnt lgkmcnt(4)
    v_mfma_f32_32x32x16_bf16 v[224:239], v[96:99], v[104:107], v[224:239]
    v_mfma_f32_32x32x16_bf16 v[224:239], v[100:103], v[108:111], v[224:239]
    ds_read_b128 v[96:99], v7 offset:1536
    ds_read_b128 v[100:103], v7 offset:1568
    v_add_u32 v12, 4294964176, v11
    v_max_i32 v12, v12, v9
    ds_read_b128 v[104:107], v12
    ds_read_b128 v[108:111], v12 offset:32
    s_waitcnt lgkmcnt(4)
    v_mfma_f32_32x32x16_bf16 v[224:239], v[170:173], v[178:181], v[224:239]
    v_mfma_f32_32x32x16_bf16 v[224:239], v[174:177], v[182:185], v[224:239]
    ds_read_b128 v[170:173], v7 offset:1472
    ds_read_b128 v[174:177], v7 offset:1504
    v_add_u32 v12, 4294964096, v11
    v_max_i32 v12, v12, v9
    ds_read_b128 v[178:181], v12
    ds_read_b128 v[182:185], v12 offset:32
    s_waitcnt lgkmcnt(4)
    v_mfma_f32_32x32x16_bf16 v[224:239], v[96:99], v[104:107], v[224:239]
    v_mfma_f32_32x32x16_bf16 v[224:239], v[100:103], v[108:111], v[224:239]
    ds_read_b128 v[96:99], v7 offset:1408
    ds_read_b128 v[100:103], v7 offset:1440
    v_add_u32 v12, 4294964016, v11
    v_max_i32 v12, v12, v9
    ds_read_b128 v[104:107], v12
    ds_read_b128 v[108:111], v12 offset:32
    s_waitcnt lgkmcnt(4)
    v_mfma_f32_32x32x16_bf16 v[224:239], v[170:173], v[178:181], v[224:239]
    v_mfma_f32_32x32x16_bf16 v[224:239], v[174:177], v[182:185], v[224:239]
    ds_read_b128 v[170:173], v7 offset:1344
    ds_read_b128 v[174:177], v7 offset:1376
    v_add_u32 v12, 4294963936, v11
    v_max_i32 v12, v12, v9
    ds_read_b128 v[178:181], v12
    ds_read_b128 v[182:185], v12 offset:32
    s_waitcnt lgkmcnt(4)
    v_mfma_f32_32x32x16_bf16 v[224:239], v[96:99], v[104:107], v[224:239]
    v_mfma_f32_32x32x16_bf16 v[224:239], v[100:103], v[108:111], v[224:239]
    ds_read_b128 v[96:99], v7 offset:1280
    ds_read_b128 v[100:103], v7 offset:1312
    v_add_u32 v12, 4294963856, v11
    v_max_i32 v12, v12, v9
    ds_read_b128 v[104:107], v12
    ds_read_b128 v[108:111], v12 offset:32
    s_waitcnt lgkmcnt(4)
    v_mfma_f32_32x32x16_bf16 v[224:239], v[170:173], v[178:181], v[224:239]
    v_mfma_f32_32x32x16_bf16 v[224:239], v[174:177], v[182:185], v[224:239]
    ds_read_b128 v[170:173], v7 offset:1216
    ds_read_b128 v[174:177], v7 offset:1248
    v_add_u32 v12, 4294963776, v11
    v_max_i32 v12, v12, v9
    ds_read_b128 v[178:181], v12
    ds_read_b128 v[182:185], v12 offset:32
    s_waitcnt lgkmcnt(4)
    v_mfma_f32_32x32x16_bf16 v[224:239], v[96:99], v[104:107], v[224:239]
    v_mfma_f32_32x32x16_bf16 v[224:239], v[100:103], v[108:111], v[224:239]
    ds_read_b128 v[96:99], v7 offset:1152
    ds_read_b128 v[100:103], v7 offset:1184
    v_add_u32 v12, 4294963696, v11
    v_max_i32 v12, v12, v9
    ds_read_b128 v[104:107], v12
    ds_read_b128 v[108:111], v12 offset:32
    s_waitcnt lgkmcnt(4)
    v_mfma_f32_32x32x16_bf16 v[224:239], v[170:173], v[178:181], v[224:239]
    v_mfma_f32_32x32x16_bf16 v[224:239], v[174:177], v[182:185], v[224:239]
    ds_read_b128 v[170:173], v7 offset:1088
    ds_read_b128 v[174:177], v7 offset:1120
    v_add_u32 v12, 4294963616, v11
    v_max_i32 v12, v12, v9
    ds_read_b128 v[178:181], v12
    ds_read_b128 v[182:185], v12 offset:32
    s_waitcnt lgkmcnt(4)
    v_mfma_f32_32x32x16_bf16 v[224:239], v[96:99], v[104:107], v[224:239]
    v_mfma_f32_32x32x16_bf16 v[224:239], v[100:103], v[108:111], v[224:239]
    ds_read_b128 v[96:99], v7 offset:1024
    ds_read_b128 v[100:103], v7 offset:1056
    v_add_u32 v12, 4294963536, v11
    v_max_i32 v12, v12, v9
    ds_read_b128 v[104:107], v12
    ds_read_b128 v[108:111], v12 offset:32
    s_waitcnt lgkmcnt(4)
    v_mfma_f32_32x32x16_bf16 v[224:239], v[170:173], v[178:181], v[224:239]
    v_mfma_f32_32x32x16_bf16 v[224:239], v[174:177], v[182:185], v[224:239]
    ds_read_b128 v[170:173], v7 offset:960
    ds_read_b128 v[174:177], v7 offset:992
    v_add_u32 v12, 4294963456, v11
    v_max_i32 v12, v12, v9
    ds_read_b128 v[178:181], v12
    ds_read_b128 v[182:185], v12 offset:32
    s_waitcnt lgkmcnt(4)
    v_mfma_f32_32x32x16_bf16 v[224:239], v[96:99], v[104:107], v[224:239]
    v_mfma_f32_32x32x16_bf16 v[224:239], v[100:103], v[108:111], v[224:239]
    ds_read_b128 v[96:99], v7 offset:896
    ds_read_b128 v[100:103], v7 offset:928
    v_add_u32 v12, 4294963376, v11
    v_max_i32 v12, v12, v9
    ds_read_b128 v[104:107], v12
    ds_read_b128 v[108:111], v12 offset:32
    s_waitcnt lgkmcnt(4)
    v_mfma_f32_32x32x16_bf16 v[224:239], v[170:173], v[178:181], v[224:239]
    v_mfma_f32_32x32x16_bf16 v[224:239], v[174:177], v[182:185], v[224:239]
    ds_read_b128 v[170:173], v7 offset:832
    ds_read_b128 v[174:177], v7 offset:864
    v_add_u32 v12, 4294963296, v11
    v_max_i32 v12, v12, v9
    ds_read_b128 v[178:181], v12
    ds_read_b128 v[182:185], v12 offset:32
    s_waitcnt lgkmcnt(4)
    v_mfma_f32_32x32x16_bf16 v[224:239], v[96:99], v[104:107], v[224:239]
    v_mfma_f32_32x32x16_bf16 v[224:239], v[100:103], v[108:111], v[224:239]
    ds_read_b128 v[96:99], v7 offset:768
    ds_read_b128 v[100:103], v7 offset:800
    v_add_u32 v12, 4294963216, v11
    v_max_i32 v12, v12, v9
    ds_read_b128 v[104:107], v12
    ds_read_b128 v[108:111], v12 offset:32
    s_waitcnt lgkmcnt(4)
    v_mfma_f32_32x32x16_bf16 v[224:239], v[170:173], v[178:181], v[224:239]
    v_mfma_f32_32x32x16_bf16 v[224:239], v[174:177], v[182:185], v[224:239]
    ds_read_b128 v[170:173], v7 offset:704
    ds_read_b128 v[174:177], v7 offset:736
    v_add_u32 v12, 4294963136, v11
    v_max_i32 v12, v12, v9
    ds_read_b128 v[178:181], v12
    ds_read_b128 v[182:185], v12 offset:32
    s_waitcnt lgkmcnt(4)
    v_mfma_f32_32x32x16_bf16 v[224:239], v[96:99], v[104:107], v[224:239]
    v_mfma_f32_32x32x16_bf16 v[224:239], v[100:103], v[108:111], v[224:239]
    ds_read_b128 v[96:99], v7 offset:640
    ds_read_b128 v[100:103], v7 offset:672
    v_add_u32 v12, 4294963056, v11
    v_max_i32 v12, v12, v9
    ds_read_b128 v[104:107], v12
    ds_read_b128 v[108:111], v12 offset:32
    s_waitcnt lgkmcnt(4)
    v_mfma_f32_32x32x16_bf16 v[224:239], v[170:173], v[178:181], v[224:239]
    v_mfma_f32_32x32x16_bf16 v[224:239], v[174:177], v[182:185], v[224:239]
    ds_read_b128 v[170:173], v7 offset:576
    ds_read_b128 v[174:177], v7 offset:608
    v_add_u32 v12, 4294962976, v11
    v_max_i32 v12, v12, v9
    ds_read_b128 v[178:181], v12
    ds_read_b128 v[182:185], v12 offset:32
    s_waitcnt lgkmcnt(4)
    v_mfma_f32_32x32x16_bf16 v[224:239], v[96:99], v[104:107], v[224:239]
    v_mfma_f32_32x32x16_bf16 v[224:239], v[100:103], v[108:111], v[224:239]
    ds_read_b128 v[96:99], v7 offset:512
    ds_read_b128 v[100:103], v7 offset:544
    v_add_u32 v12, 4294962896, v11
    v_max_i32 v12, v12, v9
    ds_read_b128 v[104:107], v12
    ds_read_b128 v[108:111], v12 offset:32
    s_waitcnt lgkmcnt(4)
    v_mfma_f32_32x32x16_bf16 v[224:239], v[170:173], v[178:181], v[224:239]
    v_mfma_f32_32x32x16_bf16 v[224:239], v[174:177], v[182:185], v[224:239]
    ds_read_b128 v[170:173], v7 offset:448
    ds_read_b128 v[174:177], v7 offset:480
    v_add_u32 v12, 4294962816, v11
    v_max_i32 v12, v12, v9
    ds_read_b128 v[178:181], v12
    ds_read_b128 v[182:185], v12 offset:32
    s_waitcnt lgkmcnt(4)
    v_mfma_f32_32x32x16_bf16 v[224:239], v[96:99], v[104:107], v[224:239]
    v_mfma_f32_32x32x16_bf16 v[224:239], v[100:103], v[108:111], v[224:239]
    ds_read_b128 v[96:99], v7 offset:384
    ds_read_b128 v[100:103], v7 offset:416
    v_add_u32 v12, 4294962736, v11
    v_max_i32 v12, v12, v9
    ds_read_b128 v[104:107], v12
    ds_read_b128 v[108:111], v12 offset:32
    s_waitcnt lgkmcnt(4)
    v_mfma_f32_32x32x16_bf16 v[224:239], v[170:173], v[178:181], v[224:239]
    v_mfma_f32_32x32x16_bf16 v[224:239], v[174:177], v[182:185], v[224:239]
    ds_read_b128 v[170:173], v7 offset:320
    ds_read_b128 v[174:177], v7 offset:352
    v_add_u32 v12, 4294962656, v11
    v_max_i32 v12, v12, v9
    ds_read_b128 v[178:181], v12
    ds_read_b128 v[182:185], v12 offset:32
    s_waitcnt lgkmcnt(4)
    v_mfma_f32_32x32x16_bf16 v[224:239], v[96:99], v[104:107], v[224:239]
    v_mfma_f32_32x32x16_bf16 v[224:239], v[100:103], v[108:111], v[224:239]
    ds_read_b128 v[96:99], v7 offset:256
    ds_read_b128 v[100:103], v7 offset:288
    v_add_u32 v12, 4294962576, v11
    v_max_i32 v12, v12, v9
    ds_read_b128 v[104:107], v12
    ds_read_b128 v[108:111], v12 offset:32
    s_waitcnt lgkmcnt(4)
    v_mfma_f32_32x32x16_bf16 v[224:239], v[170:173], v[178:181], v[224:239]
    v_mfma_f32_32x32x16_bf16 v[224:239], v[174:177], v[182:185], v[224:239]
    ds_read_b128 v[170:173], v7 offset:192
    ds_read_b128 v[174:177], v7 offset:224
    v_add_u32 v12, 4294962496, v11
    v_max_i32 v12, v12, v9
    ds_read_b128 v[178:181], v12
    ds_read_b128 v[182:185], v12 offset:32
    s_waitcnt lgkmcnt(4)
    v_mfma_f32_32x32x16_bf16 v[224:239], v[96:99], v[104:107], v[224:239]
    v_mfma_f32_32x32x16_bf16 v[224:239], v[100:103], v[108:111], v[224:239]
    ds_read_b128 v[96:99], v7 offset:128
    ds_read_b128 v[100:103], v7 offset:160
    v_add_u32 v12, 4294962416, v11
    v_max_i32 v12, v12, v9
    ds_read_b128 v[104:107], v12
    ds_read_b128 v[108:111], v12 offset:32
    s_waitcnt lgkmcnt(4)
    v_mfma_f32_32x32x16_bf16 v[224:239], v[170:173], v[178:181], v[224:239]
    v_mfma_f32_32x32x16_bf16 v[224:239], v[174:177], v[182:185], v[224:239]
    ds_read_b128 v[170:173], v7 offset:64
    ds_read_b128 v[174:177], v7 offset:96
    v_add_u32 v12, 4294962336, v11
    v_max_i32 v12, v12, v9
    ds_read_b128 v[178:181], v12
    ds_read_b128 v[182:185], v12 offset:32
    s_waitcnt lgkmcnt(4)
    v_mfma_f32_32x32x16_bf16 v[224:239], v[96:99], v[104:107], v[224:239]
    v_mfma_f32_32x32x16_bf16 v[224:239], v[100:103], v[108:111], v[224:239]
    ds_read_b128 v[96:99], v7 offset:0
    ds_read_b128 v[100:103], v7 offset:32
    v_add_u32 v12, 4294962256, v11
    v_max_i32 v12, v12, v9
    ds_read_b128 v[104:107], v12
    ds_read_b128 v[108:111], v12 offset:32
    s_waitcnt lgkmcnt(4)
    v_mfma_f32_32x32x16_bf16 v[224:239], v[170:173], v[178:181], v[224:239]
    v_mfma_f32_32x32x16_bf16 v[224:239], v[174:177], v[182:185], v[224:239]
    s_waitcnt lgkmcnt(0)
    v_mfma_f32_32x32x16_bf16 v[224:239], v[96:99], v[104:107], v[224:239]
    v_mfma_f32_32x32x16_bf16 v[224:239], v[100:103], v[108:111], v[224:239]
    s_nop 15
    v_lshlrev_b32 v12, 6, v4
    v_lshl_add_u32 v12, v5, 3, v12
    v_add_u32 v12, s25, v12
    v_cvt_pk_bf16_f32 v14, v208, v209
    v_cvt_pk_bf16_f32 v15, v210, v211
    ds_write_b64 v12, v[14:15] offset:0
    s_nop 1
    v_cvt_pk_bf16_f32 v14, v212, v213
    v_cvt_pk_bf16_f32 v15, v214, v215
    ds_write_b64 v12, v[14:15] offset:16
    s_nop 1
    v_cvt_pk_bf16_f32 v14, v216, v217
    v_cvt_pk_bf16_f32 v15, v218, v219
    ds_write_b64 v12, v[14:15] offset:32
    s_nop 1
    v_cvt_pk_bf16_f32 v14, v220, v221
    v_cvt_pk_bf16_f32 v15, v222, v223
    ds_write_b64 v12, v[14:15] offset:48
    s_nop 1
    v_cvt_pk_bf16_f32 v14, v224, v225
    v_cvt_pk_bf16_f32 v15, v226, v227
    ds_write_b64 v12, v[14:15] offset:2048
    s_nop 1
    v_cvt_pk_bf16_f32 v14, v228, v229
    v_cvt_pk_bf16_f32 v15, v230, v231
    ds_write_b64 v12, v[14:15] offset:2064
    s_nop 1
    v_cvt_pk_bf16_f32 v14, v232, v233
    v_cvt_pk_bf16_f32 v15, v234, v235
    ds_write_b64 v12, v[14:15] offset:2080
    s_nop 1
    v_cvt_pk_bf16_f32 v14, v236, v237
    v_cvt_pk_bf16_f32 v15, v238, v239
    ds_write_b64 v12, v[14:15] offset:2096
    s_nop 1
    s_waitcnt lgkmcnt(0)
    s_barrier
    v_lshlrev_b32 v12, 4, v0
    v_add_u32 v13, 0, v12
    ds_read_b128 v[170:173], v13
    v_add_u32 v13, 38480, v12
    ds_read_b128 v[174:177], v13
    v_add_u32 v13, 76960, v12
    ds_read_b128 v[178:181], v13
    v_add_u32 v13, 115440, v12
    ds_read_b128 v[182:185], v13
    s_waitcnt lgkmcnt(0)
    s_movk_i32 s23, 0x5000
    v_mul_lo_u32 v3, v0, s23
    v_add_u32 v3, s3, v3
    v_lshlrev_b32 v7, 16, v170
    v_mul_f32 v8, s86, v130
    v_cvt_pk_bf16_f32 v8, v8, v8
    v_lshlrev_b32 v8, 16, v8
    v_add_f32 v7, v7, v8
    v_cvt_pk_bf16_f32 v7, v7, v7
    v_lshlrev_b32 v7, 16, v7
    v_lshlrev_b32 v8, 16, v58
    v_mul_f32 v16, v7, v8
    v_lshlrev_b32 v7, 16, v174
    v_mul_f32 v8, s87, v138
    v_cvt_pk_bf16_f32 v8, v8, v8
    v_lshlrev_b32 v8, 16, v8
    v_add_f32 v7, v7, v8
    v_cvt_pk_bf16_f32 v7, v7, v7
    v_lshlrev_b32 v7, 16, v7
    v_and_b32 v8, 0xffff0000, v58
    v_mul_f32 v17, v7, v8
    v_lshlrev_b32 v7, 16, v178
    v_mul_f32 v8, s88, v146
    v_cvt_pk_bf16_f32 v8, v8, v8
    v_lshlrev_b32 v8, 16, v8
    v_add_f32 v7, v7, v8
    v_cvt_pk_bf16_f32 v7, v7, v7
    v_lshlrev_b32 v7, 16, v7
    v_lshlrev_b32 v8, 16, v59
    v_mul_f32 v18, v7, v8
    v_lshlrev_b32 v7, 16, v182
    v_mul_f32 v8, s89, v154
    v_cvt_pk_bf16_f32 v8, v8, v8
    v_lshlrev_b32 v8, 16, v8
    v_add_f32 v7, v7, v8
    v_cvt_pk_bf16_f32 v7, v7, v7
    v_lshlrev_b32 v7, 16, v7
    v_and_b32 v8, 0xffff0000, v59
    v_mul_f32 v19, v7, v8
    v_cvt_pk_bf16_f32 v14, v16, v17
    v_cvt_pk_bf16_f32 v15, v18, v19
    v_add_u32 v4, 0, v3
    buffer_store_dwordx2 v[14:15], v4, s[56:59], 0 offen
    s_nop 1
    v_and_b32 v7, 0xffff0000, v170
    v_mul_f32 v8, s86, v131
    v_cvt_pk_bf16_f32 v8, v8, v8
    v_lshlrev_b32 v8, 16, v8
    v_add_f32 v7, v7, v8
    v_cvt_pk_bf16_f32 v7, v7, v7
    v_lshlrev_b32 v7, 16, v7
    v_lshlrev_b32 v8, 16, v60
    v_mul_f32 v16, v7, v8
    v_and_b32 v7, 0xffff0000, v174
    v_mul_f32 v8, s87, v139
    v_cvt_pk_bf16_f32 v8, v8, v8
    v_lshlrev_b32 v8, 16, v8
    v_add_f32 v7, v7, v8
    v_cvt_pk_bf16_f32 v7, v7, v7
    v_lshlrev_b32 v7, 16, v7
    v_and_b32 v8, 0xffff0000, v60
    v_mul_f32 v17, v7, v8
    v_and_b32 v7, 0xffff0000, v178
    v_mul_f32 v8, s88, v147
    v_cvt_pk_bf16_f32 v8, v8, v8
    v_lshlrev_b32 v8, 16, v8
    v_add_f32 v7, v7, v8
    v_cvt_pk_bf16_f32 v7, v7, v7
    v_lshlrev_b32 v7, 16, v7
    v_lshlrev_b32 v8, 16, v61
    v_mul_f32 v18, v7, v8
    v_and_b32 v7, 0xffff0000, v182
    v_mul_f32 v8, s89, v155
    v_cvt_pk_bf16_f32 v8, v8, v8
    v_lshlrev_b32 v8, 16, v8
    v_add_f32 v7, v7, v8
    v_cvt_pk_bf16_f32 v7, v7, v7
    v_lshlrev_b32 v7, 16, v7
    v_and_b32 v8, 0xffff0000, v61
    v_mul_f32 v19, v7, v8
    v_cvt_pk_bf16_f32 v14, v16, v17
    v_cvt_pk_bf16_f32 v15, v18, v19
    v_add_u32 v4, 2560, v3
    buffer_store_dwordx2 v[14:15], v4, s[56:59], 0 offen
    s_nop 1
    v_lshlrev_b32 v7, 16, v171
    v_mul_f32 v8, s86, v132
    v_cvt_pk_bf16_f32 v8, v8, v8
    v_lshlrev_b32 v8, 16, v8
    v_add_f32 v7, v7, v8
    v_cvt_pk_bf16_f32 v7, v7, v7
    v_lshlrev_b32 v7, 16, v7
    v_lshlrev_b32 v8, 16, v62
    v_mul_f32 v16, v7, v8
    v_lshlrev_b32 v7, 16, v175
    v_mul_f32 v8, s87, v140
    v_cvt_pk_bf16_f32 v8, v8, v8
    v_lshlrev_b32 v8, 16, v8
    v_add_f32 v7, v7, v8
    v_cvt_pk_bf16_f32 v7, v7, v7
    v_lshlrev_b32 v7, 16, v7
    v_and_b32 v8, 0xffff0000, v62
    v_mul_f32 v17, v7, v8
    v_lshlrev_b32 v7, 16, v179
    v_mul_f32 v8, s88, v148
    v_cvt_pk_bf16_f32 v8, v8, v8
    v_lshlrev_b32 v8, 16, v8
    v_add_f32 v7, v7, v8
    v_cvt_pk_bf16_f32 v7, v7, v7
    v_lshlrev_b32 v7, 16, v7
    v_lshlrev_b32 v8, 16, v63
    v_mul_f32 v18, v7, v8
    v_lshlrev_b32 v7, 16, v183
    v_mul_f32 v8, s89, v156
    v_cvt_pk_bf16_f32 v8, v8, v8
    v_lshlrev_b32 v8, 16, v8
    v_add_f32 v7, v7, v8
    v_cvt_pk_bf16_f32 v7, v7, v7
    v_lshlrev_b32 v7, 16, v7
    v_and_b32 v8, 0xffff0000, v63
    v_mul_f32 v19, v7, v8
    v_cvt_pk_bf16_f32 v14, v16, v17
    v_cvt_pk_bf16_f32 v15, v18, v19
    v_add_u32 v4, 5120, v3
    buffer_store_dwordx2 v[14:15], v4, s[56:59], 0 offen
    s_nop 1
    v_and_b32 v7, 0xffff0000, v171
    v_mul_f32 v8, s86, v133
    v_cvt_pk_bf16_f32 v8, v8, v8
    v_lshlrev_b32 v8, 16, v8
    v_add_f32 v7, v7, v8
    v_cvt_pk_bf16_f32 v7, v7, v7
    v_lshlrev_b32 v7, 16, v7
    v_lshlrev_b32 v8, 16, v64
    v_mul_f32 v16, v7, v8
    v_and_b32 v7, 0xffff0000, v175
    v_mul_f32 v8, s87, v141
    v_cvt_pk_bf16_f32 v8, v8, v8
    v_lshlrev_b32 v8, 16, v8
    v_add_f32 v7, v7, v8
    v_cvt_pk_bf16_f32 v7, v7, v7
    v_lshlrev_b32 v7, 16, v7
    v_and_b32 v8, 0xffff0000, v64
    v_mul_f32 v17, v7, v8
    v_and_b32 v7, 0xffff0000, v179
    v_mul_f32 v8, s88, v149
    v_cvt_pk_bf16_f32 v8, v8, v8
    v_lshlrev_b32 v8, 16, v8
    v_add_f32 v7, v7, v8
    v_cvt_pk_bf16_f32 v7, v7, v7
    v_lshlrev_b32 v7, 16, v7
    v_lshlrev_b32 v8, 16, v65
    v_mul_f32 v18, v7, v8
    v_and_b32 v7, 0xffff0000, v183
    v_mul_f32 v8, s89, v157
    v_cvt_pk_bf16_f32 v8, v8, v8
    v_lshlrev_b32 v8, 16, v8
    v_add_f32 v7, v7, v8
    v_cvt_pk_bf16_f32 v7, v7, v7
    v_lshlrev_b32 v7, 16, v7
    v_and_b32 v8, 0xffff0000, v65
    v_mul_f32 v19, v7, v8
    v_cvt_pk_bf16_f32 v14, v16, v17
    v_cvt_pk_bf16_f32 v15, v18, v19
    v_add_u32 v4, 7680, v3
    buffer_store_dwordx2 v[14:15], v4, s[56:59], 0 offen
    s_nop 1
    v_lshlrev_b32 v7, 16, v172
    v_mul_f32 v8, s86, v134
    v_cvt_pk_bf16_f32 v8, v8, v8
    v_lshlrev_b32 v8, 16, v8
    v_add_f32 v7, v7, v8
    v_cvt_pk_bf16_f32 v7, v7, v7
    v_lshlrev_b32 v7, 16, v7
    v_lshlrev_b32 v8, 16, v66
    v_mul_f32 v16, v7, v8
    v_lshlrev_b32 v7, 16, v176
    v_mul_f32 v8, s87, v142
    v_cvt_pk_bf16_f32 v8, v8, v8
    v_lshlrev_b32 v8, 16, v8
    v_add_f32 v7, v7, v8
    v_cvt_pk_bf16_f32 v7, v7, v7
    v_lshlrev_b32 v7, 16, v7
    v_and_b32 v8, 0xffff0000, v66
    v_mul_f32 v17, v7, v8
    v_lshlrev_b32 v7, 16, v180
    v_mul_f32 v8, s88, v150
    v_cvt_pk_bf16_f32 v8, v8, v8
    v_lshlrev_b32 v8, 16, v8
    v_add_f32 v7, v7, v8
    v_cvt_pk_bf16_f32 v7, v7, v7
    v_lshlrev_b32 v7, 16, v7
    v_lshlrev_b32 v8, 16, v67
    v_mul_f32 v18, v7, v8
    v_lshlrev_b32 v7, 16, v184
    v_mul_f32 v8, s89, v158
    v_cvt_pk_bf16_f32 v8, v8, v8
    v_lshlrev_b32 v8, 16, v8
    v_add_f32 v7, v7, v8
    v_cvt_pk_bf16_f32 v7, v7, v7
    v_lshlrev_b32 v7, 16, v7
    v_and_b32 v8, 0xffff0000, v67
    v_mul_f32 v19, v7, v8
    v_cvt_pk_bf16_f32 v14, v16, v17
    v_cvt_pk_bf16_f32 v15, v18, v19
    v_add_u32 v4, 10240, v3
    buffer_store_dwordx2 v[14:15], v4, s[56:59], 0 offen
    s_nop 1
    v_and_b32 v7, 0xffff0000, v172
    v_mul_f32 v8, s86, v135
    v_cvt_pk_bf16_f32 v8, v8, v8
    v_lshlrev_b32 v8, 16, v8
    v_add_f32 v7, v7, v8
    v_cvt_pk_bf16_f32 v7, v7, v7
    v_lshlrev_b32 v7, 16, v7
    v_lshlrev_b32 v8, 16, v68
    v_mul_f32 v16, v7, v8
    v_and_b32 v7, 0xffff0000, v176
    v_mul_f32 v8, s87, v143
    v_cvt_pk_bf16_f32 v8, v8, v8
    v_lshlrev_b32 v8, 16, v8
    v_add_f32 v7, v7, v8
    v_cvt_pk_bf16_f32 v7, v7, v7
    v_lshlrev_b32 v7, 16, v7
    v_and_b32 v8, 0xffff0000, v68
    v_mul_f32 v17, v7, v8
    v_and_b32 v7, 0xffff0000, v180
    v_mul_f32 v8, s88, v151
    v_cvt_pk_bf16_f32 v8, v8, v8
    v_lshlrev_b32 v8, 16, v8
    v_add_f32 v7, v7, v8
    v_cvt_pk_bf16_f32 v7, v7, v7
    v_lshlrev_b32 v7, 16, v7
    v_lshlrev_b32 v8, 16, v69
    v_mul_f32 v18, v7, v8
    v_and_b32 v7, 0xffff0000, v184
    v_mul_f32 v8, s89, v159
    v_cvt_pk_bf16_f32 v8, v8, v8
    v_lshlrev_b32 v8, 16, v8
    v_add_f32 v7, v7, v8
    v_cvt_pk_bf16_f32 v7, v7, v7
    v_lshlrev_b32 v7, 16, v7
    v_and_b32 v8, 0xffff0000, v69
    v_mul_f32 v19, v7, v8
    v_cvt_pk_bf16_f32 v14, v16, v17
    v_cvt_pk_bf16_f32 v15, v18, v19
    v_add_u32 v4, 12800, v3
    buffer_store_dwordx2 v[14:15], v4, s[56:59], 0 offen
    s_nop 1
    v_lshlrev_b32 v7, 16, v173
    v_mul_f32 v8, s86, v136
    v_cvt_pk_bf16_f32 v8, v8, v8
    v_lshlrev_b32 v8, 16, v8
    v_add_f32 v7, v7, v8
    v_cvt_pk_bf16_f32 v7, v7, v7
    v_lshlrev_b32 v7, 16, v7
    v_lshlrev_b32 v8, 16, v70
    v_mul_f32 v16, v7, v8
    v_lshlrev_b32 v7, 16, v177
    v_mul_f32 v8, s87, v144
    v_cvt_pk_bf16_f32 v8, v8, v8
    v_lshlrev_b32 v8, 16, v8
    v_add_f32 v7, v7, v8
    v_cvt_pk_bf16_f32 v7, v7, v7
    v_lshlrev_b32 v7, 16, v7
    v_and_b32 v8, 0xffff0000, v70
    v_mul_f32 v17, v7, v8
    v_lshlrev_b32 v7, 16, v181
    v_mul_f32 v8, s88, v152
    v_cvt_pk_bf16_f32 v8, v8, v8
    v_lshlrev_b32 v8, 16, v8
    v_add_f32 v7, v7, v8
    v_cvt_pk_bf16_f32 v7, v7, v7
    v_lshlrev_b32 v7, 16, v7
    v_lshlrev_b32 v8, 16, v71
    v_mul_f32 v18, v7, v8
    v_lshlrev_b32 v7, 16, v185
    v_mul_f32 v8, s89, v160
    v_cvt_pk_bf16_f32 v8, v8, v8
    v_lshlrev_b32 v8, 16, v8
    v_add_f32 v7, v7, v8
    v_cvt_pk_bf16_f32 v7, v7, v7
    v_lshlrev_b32 v7, 16, v7
    v_and_b32 v8, 0xffff0000, v71
    v_mul_f32 v19, v7, v8
    v_cvt_pk_bf16_f32 v14, v16, v17
    v_cvt_pk_bf16_f32 v15, v18, v19
    v_add_u32 v4, 15360, v3
    buffer_store_dwordx2 v[14:15], v4, s[56:59], 0 offen
    s_nop 1
    v_and_b32 v7, 0xffff0000, v173
    v_mul_f32 v8, s86, v137
    v_cvt_pk_bf16_f32 v8, v8, v8
    v_lshlrev_b32 v8, 16, v8
    v_add_f32 v7, v7, v8
    v_cvt_pk_bf16_f32 v7, v7, v7
    v_lshlrev_b32 v7, 16, v7
    v_lshlrev_b32 v8, 16, v72
    v_mul_f32 v16, v7, v8
    v_and_b32 v7, 0xffff0000, v177
    v_mul_f32 v8, s87, v145
    v_cvt_pk_bf16_f32 v8, v8, v8
    v_lshlrev_b32 v8, 16, v8
    v_add_f32 v7, v7, v8
    v_cvt_pk_bf16_f32 v7, v7, v7
    v_lshlrev_b32 v7, 16, v7
    v_and_b32 v8, 0xffff0000, v72
    v_mul_f32 v17, v7, v8
    v_and_b32 v7, 0xffff0000, v181
    v_mul_f32 v8, s88, v153
    v_cvt_pk_bf16_f32 v8, v8, v8
    v_lshlrev_b32 v8, 16, v8
    v_add_f32 v7, v7, v8
    v_cvt_pk_bf16_f32 v7, v7, v7
    v_lshlrev_b32 v7, 16, v7
    v_lshlrev_b32 v8, 16, v73
    v_mul_f32 v18, v7, v8
    v_and_b32 v7, 0xffff0000, v185
    v_mul_f32 v8, s89, v161
    v_cvt_pk_bf16_f32 v8, v8, v8
    v_lshlrev_b32 v8, 16, v8
    v_add_f32 v7, v7, v8
    v_cvt_pk_bf16_f32 v7, v7, v7
    v_lshlrev_b32 v7, 16, v7
    v_and_b32 v8, 0xffff0000, v73
    v_mul_f32 v19, v7, v8
    v_cvt_pk_bf16_f32 v14, v16, v17
    v_cvt_pk_bf16_f32 v15, v18, v19
    v_add_u32 v4, 17920, v3
    buffer_store_dwordx2 v[14:15], v4, s[56:59], 0 offen
    s_nop 1
    s_endpgm
L_stage1:
    s_load_dwordx2 s[4:5], s[0:1], 48
    s_load_dwordx4 s[44:47], s[0:1], 72
    s_load_dwordx2 s[48:49], s[0:1], 104
    s_sub_u32 s3, s2, 160
    s_and_b32 s50, s3, 15
    s_lshr_b32 s51, s3, 4
    s_waitcnt lgkmcnt(0)
    s_cmp_ge_u32 s51, 5
    s_cselect_b32 s44, s46, s44
    s_cselect_b32 s45, s47, s45
    s_cselect_b32 s52, 5, 0
    s_sub_u32 s52, s51, s52
    s_mov_b32 s8, s4
    s_mov_b32 s9, s5
    s_mov_b32 s10, 2621440
    s_mov_b32 s11, 0x00020000
    s_mov_b32 s12, s44
    s_mov_b32 s13, s45
    s_mov_b32 s14, 819200
    s_mov_b32 s15, 0x00020000
    s_mov_b32 s16, s48
    s_mov_b32 s17, s49
    s_mov_b32 s18, 5242880
    s_mov_b32 s19, 0x00020000
    s_mul_i32 s20, s50, 163840
    s_mul_i32 s21, s52, 163840
    v_lshrrev_b32 v1, 6, v0
    s_nop 1
    v_readfirstlane_b32 s22, v1
    v_and_b32 v2, 63, v0
    v_lshrrev_b32 v3, 3, v2
    v_and_b32 v4, 7, v2
    v_xor_b32 v4, v4, v3
    s_mov_b32 s23, 1280
    v_mul_lo_u32 v5, v3, s23
    v_lshl_add_u32 v5, v4, 4, v5
    s_add_u32 s30, s22, 0
    s_mul_i32 s30, s30, 10240
    s_add_u32 s30, s30, s20
    s_add_u32 s31, s22, 4
    s_mul_i32 s31, s31, 10240
    s_add_u32 s31, s31, s20
    s_add_u32 s32, s22, 8
    s_mul_i32 s32, s32, 10240
    s_add_u32 s32, s32, s20
    s_add_u32 s33, s22, 12
    s_mul_i32 s33, s33, 10240
    s_add_u32 s33, s33, s20
    s_add_u32 s34, s22, 0
    s_mul_i32 s34, s34, 10240
    s_add_u32 s34, s34, s21
    s_add_u32 s35, s22, 4
    s_mul_i32 s35, s35, 10240
    s_add_u32 s35, s35, s21
    s_add_u32 s36, s22, 8
    s_mul_i32 s36, s36, 10240
    s_add_u32 s36, s36, s21
    s_add_u32 s37, s22, 12
    s_mul_i32 s37, s37, 10240
    s_add_u32 s37, s37, s21
    s_lshl_b32 s24, s22, 10
    v_and_b32 v6, 15, v2
    v_lshrrev_b32 v7, 4, v2
    v_and_b32 v8, 7, v2
    v_xor_b32 v8, v8, v7
    v_lshlrev_b32 v8, 4, v8
    v_lshl_add_u32 v8, v6, 7, v8
    s_lshr_b32 s25, s22, 1
    s_and_b32 s26, s22, 1
    s_mul_i32 s27, s25, 8192
    s_mul_i32 s28, s26, 8192
    s_add_u32 s28, s28, 16384
    s_add_u32 s29, s27, 0
    v_add_u32 v10, s29, v8
    v_xor_b32 v11, 64, v10
    s_add_u32 s29, s28, 0
    v_add_u32 v12, s29, v8
    v_xor_b32 v13, 64, v12
    s_add_u32 s29, s27, 32768
    v_add_u32 v14, s29, v8
    v_xor_b32 v15, 64, v14
    s_add_u32 s29, s28, 32768
    v_add_u32 v16, s29, v8
    v_xor_b32 v17, 64, v16
    s_add_u32 s29, s27, 65536
    v_add_u32 v18, s29, v8
    v_xor_b32 v19, 64, v18
    s_add_u32 s29, s28, 65536
    v_add_u32 v20, s29, v8
    v_xor_b32 v21, 64, v20
    v_mov_b32 v24, 0
    v_mov_b32 v25, 0
    v_mov_b32 v26, 0
    v_mov_b32 v27, 0
    v_mov_b32 v28, 0
    v_mov_b32 v29, 0
    v_mov_b32 v30, 0
    v_mov_b32 v31, 0
    v_mov_b32 v32, 0
    v_mov_b32 v33, 0
    v_mov_b32 v34, 0
    v_mov_b32 v35, 0
    v_mov_b32 v36, 0
    v_mov_b32 v37, 0
    v_mov_b32 v38, 0
    v_mov_b32 v39, 0
    v_mov_b32 v40, 0
    v_mov_b32 v41, 0
    v_mov_b32 v42, 0
    v_mov_b32 v43, 0
    v_mov_b32 v44, 0
    v_mov_b32 v45, 0
    v_mov_b32 v46, 0
    v_mov_b32 v47, 0
    v_mov_b32 v48, 0
    v_mov_b32 v49, 0
    v_mov_b32 v50, 0
    v_mov_b32 v51, 0
    v_mov_b32 v52, 0
    v_mov_b32 v53, 0
    v_mov_b32 v54, 0
    v_mov_b32 v55, 0
    v_mov_b32 v56, 0
    v_mov_b32 v57, 0
    v_mov_b32 v58, 0
    v_mov_b32 v59, 0
    v_mov_b32 v60, 0
    v_mov_b32 v61, 0
    v_mov_b32 v62, 0
    v_mov_b32 v63, 0
    v_mov_b32 v64, 0
    v_mov_b32 v65, 0
    v_mov_b32 v66, 0
    v_mov_b32 v67, 0
    v_mov_b32 v68, 0
    v_mov_b32 v69, 0
    v_mov_b32 v70, 0
    v_mov_b32 v71, 0
    v_mov_b32 v72, 0
    v_mov_b32 v73, 0
    v_mov_b32 v74, 0
    v_mov_b32 v75, 0
    v_mov_b32 v76, 0
    v_mov_b32 v77, 0
    v_mov_b32 v78, 0
    v_mov_b32 v79, 0
    v_mov_b32 v80, 0
    v_mov_b32 v81, 0
    v_mov_b32 v82, 0
    v_mov_b32 v83, 0
    v_mov_b32 v84, 0
    v_mov_b32 v85, 0
    v_mov_b32 v86, 0
    v_mov_b32 v87, 0
    s_add_u32 m0, s24, 0
    s_nop 0
    buffer_load_dwordx4 v5, s[8:11], s30 offen lds
    s_add_u32 s30, s30, 128
    s_add_u32 m0, s24, 4096
    s_nop 0
    buffer_load_dwordx4 v5, s[8:11], s31 offen lds
    s_add_u32 s31, s31, 128
    s_add_u32 m0, s24, 8192
    s_nop 0
    buffer_load_dwordx4 v5, s[8:11], s32 offen lds
    s_add_u32 s32, s32, 128
    s_add_u32 m0, s24, 12288
    s_nop 0
    buffer_load_dwordx4 v5, s[8:11], s33 offen lds
    s_add_u32 s33, s33, 128
    s_add_u32 m0, s24, 16384
    s_nop 0
    buffer_load_dwordx4 v5, s[12:15], s34 offen lds
    s_add_u32 s34, s34, 128
    s_add_u32 m0, s24, 20480
    s_nop 0
    buffer_load_dwordx4 v5, s[12:15], s35 offen lds
    s_add_u32 s35, s35, 128
    s_add_u32 m0, s24, 24576
    s_nop 0
    buffer_load_dwordx4 v5, s[12:15], s36 offen lds
    s_add_u32 s36, s36, 128
    s_add_u32 m0, s24, 28672
    s_nop 0
    buffer_load_dwordx4 v5, s[12:15], s37 offen lds
    s_add_u32 s37, s37, 128
    s_add_u32 m0, s24, 32768
    s_nop 0
    buffer_load_dwordx4 v5, s[8:11], s30 offen lds
    s_add_u32 s30, s30, 128
    s_add_u32 m0, s24, 36864
    s_nop 0
    buffer_load_dwordx4 v5, s[8:11], s31 offen lds
    s_add_u32 s31, s31, 128
    s_add_u32 m0, s24, 40960
    s_nop 0
    buffer_load_dwordx4 v5, s[8:11], s32 offen lds
    s_add_u32 s32, s32, 128
    s_add_u32 m0, s24, 45056
    s_nop 0
    buffer_load_dwordx4 v5, s[8:11], s33 offen lds
    s_add_u32 s33, s33, 128
    s_add_u32 m0, s24, 49152
    s_nop 0
    buffer_load_dwordx4 v5, s[12:15], s34 offen lds
    s_add_u32 s34, s34, 128
    s_add_u32 m0, s24, 53248
    s_nop 0
    buffer_load_dwordx4 v5, s[12:15], s35 offen lds
    s_add_u32 s35, s35, 128
    s_add_u32 m0, s24, 57344
    s_nop 0
    buffer_load_dwordx4 v5, s[12:15], s36 offen lds
    s_add_u32 s36, s36, 128
    s_add_u32 m0, s24, 61440
    s_nop 0
    buffer_load_dwordx4 v5, s[12:15], s37 offen lds
    s_add_u32 s37, s37, 128
    s_waitcnt vmcnt(8)
    s_barrier
    s_add_u32 m0, s24, 65536
    s_nop 0
    buffer_load_dwordx4 v5, s[8:11], s30 offen lds
    s_add_u32 s30, s30, 128
    s_add_u32 m0, s24, 69632
    s_nop 0
    buffer_load_dwordx4 v5, s[8:11], s31 offen lds
    s_add_u32 s31, s31, 128
    s_add_u32 m0, s24, 73728
    s_nop 0
    buffer_load_dwordx4 v5, s[8:11], s32 offen lds
    s_add_u32 s32, s32, 128
    s_add_u32 m0, s24, 77824
    s_nop 0
    buffer_load_dwordx4 v5, s[8:11], s33 offen lds
    s_add_u32 s33, s33, 128
    s_add_u32 m0, s24, 81920
    s_nop 0
    buffer_load_dwordx4 v5, s[12:15], s34 offen lds
    s_add_u32 s34, s34, 128
    s_add_u32 m0, s24, 86016
    s_nop 0
    buffer_load_dwordx4 v5, s[12:15], s35 offen lds
    s_add_u32 s35, s35, 128
    s_add_u32 m0, s24, 90112
    s_nop 0
    buffer_load_dwordx4 v5, s[12:15], s36 offen lds
    s_add_u32 s36, s36, 128
    s_add_u32 m0, s24, 94208
    s_nop 0
    buffer_load_dwordx4 v5, s[12:15], s37 offen lds
    s_add_u32 s37, s37, 128
    ds_read_b128 v[88:91], v10 offset:0
    ds_read_b128 v[92:95], v10 offset:2048
    ds_read_b128 v[96:99], v10 offset:4096
    ds_read_b128 v[100:103], v10 offset:6144
    ds_read_b128 v[104:107], v12 offset:0
    ds_read_b128 v[108:111], v12 offset:2048
    ds_read_b128 v[112:115], v12 offset:4096
    ds_read_b128 v[116:119], v12 offset:6144
    ds_read_b128 v[120:123], v11 offset:0
    ds_read_b128 v[124:127], v11 offset:2048
    ds_read_b128 v[128:131], v11 offset:4096
    ds_read_b128 v[132:135], v11 offset:6144
    ds_read_b128 v[136:139], v13 offset:0
    ds_read_b128 v[140:143], v13 offset:2048
    ds_read_b128 v[144:147], v13 offset:4096
    ds_read_b128 v[148:151], v13 offset:6144
    s_waitcnt lgkmcnt(8)
    v_mfma_f32_16x16x32_bf16 v[24:27], v[88:91], v[104:107], v[24:27]
    v_mfma_f32_16x16x32_bf16 v[28:31], v[88:91], v[108:111], v[28:31]
    v_mfma_f32_16x16x32_bf16 v[32:35], v[88:91], v[112:115], v[32:35]
    v_mfma_f32_16x16x32_bf16 v[36:39], v[88:91], v[116:119], v[36:39]
    v_mfma_f32_16x16x32_bf16 v[40:43], v[92:95], v[104:107], v[40:43]
    v_mfma_f32_16x16x32_bf16 v[44:47], v[92:95], v[108:111], v[44:47]
    v_mfma_f32_16x16x32_bf16 v[48:51], v[92:95], v[112:115], v[48:51]
    v_mfma_f32_16x16x32_bf16 v[52:55], v[92:95], v[116:119], v[52:55]
    v_mfma_f32_16x16x32_bf16 v[56:59], v[96:99], v[104:107], v[56:59]
    v_mfma_f32_16x16x32_bf16 v[60:63], v[96:99], v[108:111], v[60:63]
    v_mfma_f32_16x16x32_bf16 v[64:67], v[96:99], v[112:115], v[64:67]
    v_mfma_f32_16x16x32_bf16 v[68:71], v[96:99], v[116:119], v[68:71]
    v_mfma_f32_16x16x32_bf16 v[72:75], v[100:103], v[104:107], v[72:75]
    v_mfma_f32_16x16x32_bf16 v[76:79], v[100:103], v[108:111], v[76:79]
    v_mfma_f32_16x16x32_bf16 v[80:83], v[100:103], v[112:115], v[80:83]
    v_mfma_f32_16x16x32_bf16 v[84:87], v[100:103], v[116:119], v[84:87]
    s_waitcnt lgkmcnt(0)
    v_mfma_f32_16x16x32_bf16 v[24:27], v[120:123], v[136:139], v[24:27]
    v_mfma_f32_16x16x32_bf16 v[28:31], v[120:123], v[140:143], v[28:31]
    v_mfma_f32_16x16x32_bf16 v[32:35], v[120:123], v[144:147], v[32:35]
    v_mfma_f32_16x16x32_bf16 v[36:39], v[120:123], v[148:151], v[36:39]
    v_mfma_f32_16x16x32_bf16 v[40:43], v[124:127], v[136:139], v[40:43]
    v_mfma_f32_16x16x32_bf16 v[44:47], v[124:127], v[140:143], v[44:47]
    v_mfma_f32_16x16x32_bf16 v[48:51], v[124:127], v[144:147], v[48:51]
    v_mfma_f32_16x16x32_bf16 v[52:55], v[124:127], v[148:151], v[52:55]
    v_mfma_f32_16x16x32_bf16 v[56:59], v[128:131], v[136:139], v[56:59]
    v_mfma_f32_16x16x32_bf16 v[60:63], v[128:131], v[140:143], v[60:63]
    v_mfma_f32_16x16x32_bf16 v[64:67], v[128:131], v[144:147], v[64:67]
    v_mfma_f32_16x16x32_bf16 v[68:71], v[128:131], v[148:151], v[68:71]
    v_mfma_f32_16x16x32_bf16 v[72:75], v[132:135], v[136:139], v[72:75]
    v_mfma_f32_16x16x32_bf16 v[76:79], v[132:135], v[140:143], v[76:79]
    v_mfma_f32_16x16x32_bf16 v[80:83], v[132:135], v[144:147], v[80:83]
    v_mfma_f32_16x16x32_bf16 v[84:87], v[132:135], v[148:151], v[84:87]
    s_waitcnt vmcnt(8)
    s_barrier
    s_add_u32 m0, s24, 0
    s_nop 0
    buffer_load_dwordx4 v5, s[8:11], s30 offen lds
    s_add_u32 s30, s30, 128
    s_add_u32 m0, s24, 4096
    s_nop 0
    buffer_load_dwordx4 v5, s[8:11], s31 offen lds
    s_add_u32 s31, s31, 128
    s_add_u32 m0, s24, 8192
    s_nop 0
    buffer_load_dwordx4 v5, s[8:11], s32 offen lds
    s_add_u32 s32, s32, 128
    s_add_u32 m0, s24, 12288
    s_nop 0
    buffer_load_dwordx4 v5, s[8:11], s33 offen lds
    s_add_u32 s33, s33, 128
    s_add_u32 m0, s24, 16384
    s_nop 0
    buffer_load_dwordx4 v5, s[12:15], s34 offen lds
    s_add_u32 s34, s34, 128
    s_add_u32 m0, s24, 20480
    s_nop 0
    buffer_load_dwordx4 v5, s[12:15], s35 offen lds
    s_add_u32 s35, s35, 128
    s_add_u32 m0, s24, 24576
    s_nop 0
    buffer_load_dwordx4 v5, s[12:15], s36 offen lds
    s_add_u32 s36, s36, 128
    s_add_u32 m0, s24, 28672
    s_nop 0
    buffer_load_dwordx4 v5, s[12:15], s37 offen lds
    s_add_u32 s37, s37, 128
    ds_read_b128 v[88:91], v14 offset:0
    ds_read_b128 v[92:95], v14 offset:2048
    ds_read_b128 v[96:99], v14 offset:4096
    ds_read_b128 v[100:103], v14 offset:6144
    ds_read_b128 v[104:107], v16 offset:0
    ds_read_b128 v[108:111], v16 offset:2048
    ds_read_b128 v[112:115], v16 offset:4096
    ds_read_b128 v[116:119], v16 offset:6144
    ds_read_b128 v[120:123], v15 offset:0
    ds_read_b128 v[124:127], v15 offset:2048
    ds_read_b128 v[128:131], v15 offset:4096
    ds_read_b128 v[132:135], v15 offset:6144
    ds_read_b128 v[136:139], v17 offset:0
    ds_read_b128 v[140:143], v17 offset:2048
    ds_read_b128 v[144:147], v17 offset:4096
    ds_read_b128 v[148:151], v17 offset:6144
    s_waitcnt lgkmcnt(8)
    v_mfma_f32_16x16x32_bf16 v[24:27], v[88:91], v[104:107], v[24:27]
    v_mfma_f32_16x16x32_bf16 v[28:31], v[88:91], v[108:111], v[28:31]
    v_mfma_f32_16x16x32_bf16 v[32:35], v[88:91], v[112:115], v[32:35]
    v_mfma_f32_16x16x32_bf16 v[36:39], v[88:91], v[116:119], v[36:39]
    v_mfma_f32_16x16x32_bf16 v[40:43], v[92:95], v[104:107], v[40:43]
    v_mfma_f32_16x16x32_bf16 v[44:47], v[92:95], v[108:111], v[44:47]
    v_mfma_f32_16x16x32_bf16 v[48:51], v[92:95], v[112:115], v[48:51]
    v_mfma_f32_16x16x32_bf16 v[52:55], v[92:95], v[116:119], v[52:55]
    v_mfma_f32_16x16x32_bf16 v[56:59], v[96:99], v[104:107], v[56:59]
    v_mfma_f32_16x16x32_bf16 v[60:63], v[96:99], v[108:111], v[60:63]
    v_mfma_f32_16x16x32_bf16 v[64:67], v[96:99], v[112:115], v[64:67]
    v_mfma_f32_16x16x32_bf16 v[68:71], v[96:99], v[116:119], v[68:71]
    v_mfma_f32_16x16x32_bf16 v[72:75], v[100:103], v[104:107], v[72:75]
    v_mfma_f32_16x16x32_bf16 v[76:79], v[100:103], v[108:111], v[76:79]
    v_mfma_f32_16x16x32_bf16 v[80:83], v[100:103], v[112:115], v[80:83]
    v_mfma_f32_16x16x32_bf16 v[84:87], v[100:103], v[116:119], v[84:87]
    s_waitcnt lgkmcnt(0)
    v_mfma_f32_16x16x32_bf16 v[24:27], v[120:123], v[136:139], v[24:27]
    v_mfma_f32_16x16x32_bf16 v[28:31], v[120:123], v[140:143], v[28:31]
    v_mfma_f32_16x16x32_bf16 v[32:35], v[120:123], v[144:147], v[32:35]
    v_mfma_f32_16x16x32_bf16 v[36:39], v[120:123], v[148:151], v[36:39]
    v_mfma_f32_16x16x32_bf16 v[40:43], v[124:127], v[136:139], v[40:43]
    v_mfma_f32_16x16x32_bf16 v[44:47], v[124:127], v[140:143], v[44:47]
    v_mfma_f32_16x16x32_bf16 v[48:51], v[124:127], v[144:147], v[48:51]
    v_mfma_f32_16x16x32_bf16 v[52:55], v[124:127], v[148:151], v[52:55]
    v_mfma_f32_16x16x32_bf16 v[56:59], v[128:131], v[136:139], v[56:59]
    v_mfma_f32_16x16x32_bf16 v[60:63], v[128:131], v[140:143], v[60:63]
    v_mfma_f32_16x16x32_bf16 v[64:67], v[128:131], v[144:147], v[64:67]
    v_mfma_f32_16x16x32_bf16 v[68:71], v[128:131], v[148:151], v[68:71]
    v_mfma_f32_16x16x32_bf16 v[72:75], v[132:135], v[136:139], v[72:75]
    v_mfma_f32_16x16x32_bf16 v[76:79], v[132:135], v[140:143], v[76:79]
    v_mfma_f32_16x16x32_bf16 v[80:83], v[132:135], v[144:147], v[80:83]
    v_mfma_f32_16x16x32_bf16 v[84:87], v[132:135], v[148:151], v[84:87]
    s_waitcnt vmcnt(8)
    s_barrier
    s_add_u32 m0, s24, 32768
    s_nop 0
    buffer_load_dwordx4 v5, s[8:11], s30 offen lds
    s_add_u32 s30, s30, 128
    s_add_u32 m0, s24, 36864
    s_nop 0
    buffer_load_dwordx4 v5, s[8:11], s31 offen lds
    s_add_u32 s31, s31, 128
    s_add_u32 m0, s24, 40960
    s_nop 0
    buffer_load_dwordx4 v5, s[8:11], s32 offen lds
    s_add_u32 s32, s32, 128
    s_add_u32 m0, s24, 45056
    s_nop 0
    buffer_load_dwordx4 v5, s[8:11], s33 offen lds
    s_add_u32 s33, s33, 128
    s_add_u32 m0, s24, 49152
    s_nop 0
    buffer_load_dwordx4 v5, s[12:15], s34 offen lds
    s_add_u32 s34, s34, 128
    s_add_u32 m0, s24, 53248
    s_nop 0
    buffer_load_dwordx4 v5, s[12:15], s35 offen lds
    s_add_u32 s35, s35, 128
    s_add_u32 m0, s24, 57344
    s_nop 0
    buffer_load_dwordx4 v5, s[12:15], s36 offen lds
    s_add_u32 s36, s36, 128
    s_add_u32 m0, s24, 61440
    s_nop 0
    buffer_load_dwordx4 v5, s[12:15], s37 offen lds
    s_add_u32 s37, s37, 128
    ds_read_b128 v[88:91], v18 offset:0
    ds_read_b128 v[92:95], v18 offset:2048
    ds_read_b128 v[96:99], v18 offset:4096
    ds_read_b128 v[100:103], v18 offset:6144
    ds_read_b128 v[104:107], v20 offset:0
    ds_read_b128 v[108:111], v20 offset:2048
    ds_read_b128 v[112:115], v20 offset:4096
    ds_read_b128 v[116:119], v20 offset:6144
    ds_read_b128 v[120:123], v19 offset:0
    ds_read_b128 v[124:127], v19 offset:2048
    ds_read_b128 v[128:131], v19 offset:4096
    ds_read_b128 v[132:135], v19 offset:6144
    ds_read_b128 v[136:139], v21 offset:0
    ds_read_b128 v[140:143], v21 offset:2048
    ds_read_b128 v[144:147], v21 offset:4096
    ds_read_b128 v[148:151], v21 offset:6144
    s_waitcnt lgkmcnt(8)
    v_mfma_f32_16x16x32_bf16 v[24:27], v[88:91], v[104:107], v[24:27]
    v_mfma_f32_16x16x32_bf16 v[28:31], v[88:91], v[108:111], v[28:31]
    v_mfma_f32_16x16x32_bf16 v[32:35], v[88:91], v[112:115], v[32:35]
    v_mfma_f32_16x16x32_bf16 v[36:39], v[88:91], v[116:119], v[36:39]
    v_mfma_f32_16x16x32_bf16 v[40:43], v[92:95], v[104:107], v[40:43]
    v_mfma_f32_16x16x32_bf16 v[44:47], v[92:95], v[108:111], v[44:47]
    v_mfma_f32_16x16x32_bf16 v[48:51], v[92:95], v[112:115], v[48:51]
    v_mfma_f32_16x16x32_bf16 v[52:55], v[92:95], v[116:119], v[52:55]
    v_mfma_f32_16x16x32_bf16 v[56:59], v[96:99], v[104:107], v[56:59]
    v_mfma_f32_16x16x32_bf16 v[60:63], v[96:99], v[108:111], v[60:63]
    v_mfma_f32_16x16x32_bf16 v[64:67], v[96:99], v[112:115], v[64:67]
    v_mfma_f32_16x16x32_bf16 v[68:71], v[96:99], v[116:119], v[68:71]
    v_mfma_f32_16x16x32_bf16 v[72:75], v[100:103], v[104:107], v[72:75]
    v_mfma_f32_16x16x32_bf16 v[76:79], v[100:103], v[108:111], v[76:79]
    v_mfma_f32_16x16x32_bf16 v[80:83], v[100:103], v[112:115], v[80:83]
    v_mfma_f32_16x16x32_bf16 v[84:87], v[100:103], v[116:119], v[84:87]
    s_waitcnt lgkmcnt(0)
    v_mfma_f32_16x16x32_bf16 v[24:27], v[120:123], v[136:139], v[24:27]
    v_mfma_f32_16x16x32_bf16 v[28:31], v[120:123], v[140:143], v[28:31]
    v_mfma_f32_16x16x32_bf16 v[32:35], v[120:123], v[144:147], v[32:35]
    v_mfma_f32_16x16x32_bf16 v[36:39], v[120:123], v[148:151], v[36:39]
    v_mfma_f32_16x16x32_bf16 v[40:43], v[124:127], v[136:139], v[40:43]
    v_mfma_f32_16x16x32_bf16 v[44:47], v[124:127], v[140:143], v[44:47]
    v_mfma_f32_16x16x32_bf16 v[48:51], v[124:127], v[144:147], v[48:51]
    v_mfma_f32_16x16x32_bf16 v[52:55], v[124:127], v[148:151], v[52:55]
    v_mfma_f32_16x16x32_bf16 v[56:59], v[128:131], v[136:139], v[56:59]
    v_mfma_f32_16x16x32_bf16 v[60:63], v[128:131], v[140:143], v[60:63]
    v_mfma_f32_16x16x32_bf16 v[64:67], v[128:131], v[144:147], v[64:67]
    v_mfma_f32_16x16x32_bf16 v[68:71], v[128:131], v[148:151], v[68:71]
    v_mfma_f32_16x16x32_bf16 v[72:75], v[132:135], v[136:139], v[72:75]
    v_mfma_f32_16x16x32_bf16 v[76:79], v[132:135], v[140:143], v[76:79]
    v_mfma_f32_16x16x32_bf16 v[80:83], v[132:135], v[144:147], v[80:83]
    v_mfma_f32_16x16x32_bf16 v[84:87], v[132:135], v[148:151], v[84:87]
    s_waitcnt vmcnt(8)
    s_barrier
    s_add_u32 m0, s24, 65536
    s_nop 0
    buffer_load_dwordx4 v5, s[8:11], s30 offen lds
    s_add_u32 s30, s30, 128
    s_add_u32 m0, s24, 69632
    s_nop 0
    buffer_load_dwordx4 v5, s[8:11], s31 offen lds
    s_add_u32 s31, s31, 128
    s_add_u32 m0, s24, 73728
    s_nop 0
    buffer_load_dwordx4 v5, s[8:11], s32 offen lds
    s_add_u32 s32, s32, 128
    s_add_u32 m0, s24, 77824
    s_nop 0
    buffer_load_dwordx4 v5, s[8:11], s33 offen lds
    s_add_u32 s33, s33, 128
    s_add_u32 m0, s24, 81920
    s_nop 0
    buffer_load_dwordx4 v5, s[12:15], s34 offen lds
    s_add_u32 s34, s34, 128
    s_add_u32 m0, s24, 86016
    s_nop 0
    buffer_load_dwordx4 v5, s[12:15], s35 offen lds
    s_add_u32 s35, s35, 128
    s_add_u32 m0, s24, 90112
    s_nop 0
    buffer_load_dwordx4 v5, s[12:15], s36 offen lds
    s_add_u32 s36, s36, 128
    s_add_u32 m0, s24, 94208
    s_nop 0
    buffer_load_dwordx4 v5, s[12:15], s37 offen lds
    s_add_u32 s37, s37, 128
    ds_read_b128 v[88:91], v10 offset:0
    ds_read_b128 v[92:95], v10 offset:2048
    ds_read_b128 v[96:99], v10 offset:4096
    ds_read_b128 v[100:103], v10 offset:6144
    ds_read_b128 v[104:107], v12 offset:0
    ds_read_b128 v[108:111], v12 offset:2048
    ds_read_b128 v[112:115], v12 offset:4096
    ds_read_b128 v[116:119], v12 offset:6144
    ds_read_b128 v[120:123], v11 offset:0
    ds_read_b128 v[124:127], v11 offset:2048
    ds_read_b128 v[128:131], v11 offset:4096
    ds_read_b128 v[132:135], v11 offset:6144
    ds_read_b128 v[136:139], v13 offset:0
    ds_read_b128 v[140:143], v13 offset:2048
    ds_read_b128 v[144:147], v13 offset:4096
    ds_read_b128 v[148:151], v13 offset:6144
    s_waitcnt lgkmcnt(8)
    v_mfma_f32_16x16x32_bf16 v[24:27], v[88:91], v[104:107], v[24:27]
    v_mfma_f32_16x16x32_bf16 v[28:31], v[88:91], v[108:111], v[28:31]
    v_mfma_f32_16x16x32_bf16 v[32:35], v[88:91], v[112:115], v[32:35]
    v_mfma_f32_16x16x32_bf16 v[36:39], v[88:91], v[116:119], v[36:39]
    v_mfma_f32_16x16x32_bf16 v[40:43], v[92:95], v[104:107], v[40:43]
    v_mfma_f32_16x16x32_bf16 v[44:47], v[92:95], v[108:111], v[44:47]
    v_mfma_f32_16x16x32_bf16 v[48:51], v[92:95], v[112:115], v[48:51]
    v_mfma_f32_16x16x32_bf16 v[52:55], v[92:95], v[116:119], v[52:55]
    v_mfma_f32_16x16x32_bf16 v[56:59], v[96:99], v[104:107], v[56:59]
    v_mfma_f32_16x16x32_bf16 v[60:63], v[96:99], v[108:111], v[60:63]
    v_mfma_f32_16x16x32_bf16 v[64:67], v[96:99], v[112:115], v[64:67]
    v_mfma_f32_16x16x32_bf16 v[68:71], v[96:99], v[116:119], v[68:71]
    v_mfma_f32_16x16x32_bf16 v[72:75], v[100:103], v[104:107], v[72:75]
    v_mfma_f32_16x16x32_bf16 v[76:79], v[100:103], v[108:111], v[76:79]
    v_mfma_f32_16x16x32_bf16 v[80:83], v[100:103], v[112:115], v[80:83]
    v_mfma_f32_16x16x32_bf16 v[84:87], v[100:103], v[116:119], v[84:87]
    s_waitcnt lgkmcnt(0)
    v_mfma_f32_16x16x32_bf16 v[24:27], v[120:123], v[136:139], v[24:27]
    v_mfma_f32_16x16x32_bf16 v[28:31], v[120:123], v[140:143], v[28:31]
    v_mfma_f32_16x16x32_bf16 v[32:35], v[120:123], v[144:147], v[32:35]
    v_mfma_f32_16x16x32_bf16 v[36:39], v[120:123], v[148:151], v[36:39]
    v_mfma_f32_16x16x32_bf16 v[40:43], v[124:127], v[136:139], v[40:43]
    v_mfma_f32_16x16x32_bf16 v[44:47], v[124:127], v[140:143], v[44:47]
    v_mfma_f32_16x16x32_bf16 v[48:51], v[124:127], v[144:147], v[48:51]
    v_mfma_f32_16x16x32_bf16 v[52:55], v[124:127], v[148:151], v[52:55]
    v_mfma_f32_16x16x32_bf16 v[56:59], v[128:131], v[136:139], v[56:59]
    v_mfma_f32_16x16x32_bf16 v[60:63], v[128:131], v[140:143], v[60:63]
    v_mfma_f32_16x16x32_bf16 v[64:67], v[128:131], v[144:147], v[64:67]
    v_mfma_f32_16x16x32_bf16 v[68:71], v[128:131], v[148:151], v[68:71]
    v_mfma_f32_16x16x32_bf16 v[72:75], v[132:135], v[136:139], v[72:75]
    v_mfma_f32_16x16x32_bf16 v[76:79], v[132:135], v[140:143], v[76:79]
    v_mfma_f32_16x16x32_bf16 v[80:83], v[132:135], v[144:147], v[80:83]
    v_mfma_f32_16x16x32_bf16 v[84:87], v[132:135], v[148:151], v[84:87]
    s_waitcnt vmcnt(8)
    s_barrier
    s_add_u32 m0, s24, 0
    s_nop 0
    buffer_load_dwordx4 v5, s[8:11], s30 offen lds
    s_add_u32 s30, s30, 128
    s_add_u32 m0, s24, 4096
    s_nop 0
    buffer_load_dwordx4 v5, s[8:11], s31 offen lds
    s_add_u32 s31, s31, 128
    s_add_u32 m0, s24, 8192
    s_nop 0
    buffer_load_dwordx4 v5, s[8:11], s32 offen lds
    s_add_u32 s32, s32, 128
    s_add_u32 m0, s24, 12288
    s_nop 0
    buffer_load_dwordx4 v5, s[8:11], s33 offen lds
    s_add_u32 s33, s33, 128
    s_add_u32 m0, s24, 16384
    s_nop 0
    buffer_load_dwordx4 v5, s[12:15], s34 offen lds
    s_add_u32 s34, s34, 128
    s_add_u32 m0, s24, 20480
    s_nop 0
    buffer_load_dwordx4 v5, s[12:15], s35 offen lds
    s_add_u32 s35, s35, 128
    s_add_u32 m0, s24, 24576
    s_nop 0
    buffer_load_dwordx4 v5, s[12:15], s36 offen lds
    s_add_u32 s36, s36, 128
    s_add_u32 m0, s24, 28672
    s_nop 0
    buffer_load_dwordx4 v5, s[12:15], s37 offen lds
    s_add_u32 s37, s37, 128
    ds_read_b128 v[88:91], v14 offset:0
    ds_read_b128 v[92:95], v14 offset:2048
    ds_read_b128 v[96:99], v14 offset:4096
    ds_read_b128 v[100:103], v14 offset:6144
    ds_read_b128 v[104:107], v16 offset:0
    ds_read_b128 v[108:111], v16 offset:2048
    ds_read_b128 v[112:115], v16 offset:4096
    ds_read_b128 v[116:119], v16 offset:6144
    ds_read_b128 v[120:123], v15 offset:0
    ds_read_b128 v[124:127], v15 offset:2048
    ds_read_b128 v[128:131], v15 offset:4096
    ds_read_b128 v[132:135], v15 offset:6144
    ds_read_b128 v[136:139], v17 offset:0
    ds_read_b128 v[140:143], v17 offset:2048
    ds_read_b128 v[144:147], v17 offset:4096
    ds_read_b128 v[148:151], v17 offset:6144
    s_waitcnt lgkmcnt(8)
    v_mfma_f32_16x16x32_bf16 v[24:27], v[88:91], v[104:107], v[24:27]
    v_mfma_f32_16x16x32_bf16 v[28:31], v[88:91], v[108:111], v[28:31]
    v_mfma_f32_16x16x32_bf16 v[32:35], v[88:91], v[112:115], v[32:35]
    v_mfma_f32_16x16x32_bf16 v[36:39], v[88:91], v[116:119], v[36:39]
    v_mfma_f32_16x16x32_bf16 v[40:43], v[92:95], v[104:107], v[40:43]
    v_mfma_f32_16x16x32_bf16 v[44:47], v[92:95], v[108:111], v[44:47]
    v_mfma_f32_16x16x32_bf16 v[48:51], v[92:95], v[112:115], v[48:51]
    v_mfma_f32_16x16x32_bf16 v[52:55], v[92:95], v[116:119], v[52:55]
    v_mfma_f32_16x16x32_bf16 v[56:59], v[96:99], v[104:107], v[56:59]
    v_mfma_f32_16x16x32_bf16 v[60:63], v[96:99], v[108:111], v[60:63]
    v_mfma_f32_16x16x32_bf16 v[64:67], v[96:99], v[112:115], v[64:67]
    v_mfma_f32_16x16x32_bf16 v[68:71], v[96:99], v[116:119], v[68:71]
    v_mfma_f32_16x16x32_bf16 v[72:75], v[100:103], v[104:107], v[72:75]
    v_mfma_f32_16x16x32_bf16 v[76:79], v[100:103], v[108:111], v[76:79]
    v_mfma_f32_16x16x32_bf16 v[80:83], v[100:103], v[112:115], v[80:83]
    v_mfma_f32_16x16x32_bf16 v[84:87], v[100:103], v[116:119], v[84:87]
    s_waitcnt lgkmcnt(0)
    v_mfma_f32_16x16x32_bf16 v[24:27], v[120:123], v[136:139], v[24:27]
    v_mfma_f32_16x16x32_bf16 v[28:31], v[120:123], v[140:143], v[28:31]
    v_mfma_f32_16x16x32_bf16 v[32:35], v[120:123], v[144:147], v[32:35]
    v_mfma_f32_16x16x32_bf16 v[36:39], v[120:123], v[148:151], v[36:39]
    v_mfma_f32_16x16x32_bf16 v[40:43], v[124:127], v[136:139], v[40:43]
    v_mfma_f32_16x16x32_bf16 v[44:47], v[124:127], v[140:143], v[44:47]
    v_mfma_f32_16x16x32_bf16 v[48:51], v[124:127], v[144:147], v[48:51]
    v_mfma_f32_16x16x32_bf16 v[52:55], v[124:127], v[148:151], v[52:55]
    v_mfma_f32_16x16x32_bf16 v[56:59], v[128:131], v[136:139], v[56:59]
    v_mfma_f32_16x16x32_bf16 v[60:63], v[128:131], v[140:143], v[60:63]
    v_mfma_f32_16x16x32_bf16 v[64:67], v[128:131], v[144:147], v[64:67]
    v_mfma_f32_16x16x32_bf16 v[68:71], v[128:131], v[148:151], v[68:71]
    v_mfma_f32_16x16x32_bf16 v[72:75], v[132:135], v[136:139], v[72:75]
    v_mfma_f32_16x16x32_bf16 v[76:79], v[132:135], v[140:143], v[76:79]
    v_mfma_f32_16x16x32_bf16 v[80:83], v[132:135], v[144:147], v[80:83]
    v_mfma_f32_16x16x32_bf16 v[84:87], v[132:135], v[148:151], v[84:87]
    s_waitcnt vmcnt(8)
    s_barrier
    s_add_u32 m0, s24, 32768
    s_nop 0
    buffer_load_dwordx4 v5, s[8:11], s30 offen lds
    s_add_u32 s30, s30, 128
    s_add_u32 m0, s24, 36864
    s_nop 0
    buffer_load_dwordx4 v5, s[8:11], s31 offen lds
    s_add_u32 s31, s31, 128
    s_add_u32 m0, s24, 40960
    s_nop 0
    buffer_load_dwordx4 v5, s[8:11], s32 offen lds
    s_add_u32 s32, s32, 128
    s_add_u32 m0, s24, 45056
    s_nop 0
    buffer_load_dwordx4 v5, s[8:11], s33 offen lds
    s_add_u32 s33, s33, 128
    s_add_u32 m0, s24, 49152
    s_nop 0
    buffer_load_dwordx4 v5, s[12:15], s34 offen lds
    s_add_u32 s34, s34, 128
    s_add_u32 m0, s24, 53248
    s_nop 0
    buffer_load_dwordx4 v5, s[12:15], s35 offen lds
    s_add_u32 s35, s35, 128
    s_add_u32 m0, s24, 57344
    s_nop 0
    buffer_load_dwordx4 v5, s[12:15], s36 offen lds
    s_add_u32 s36, s36, 128
    s_add_u32 m0, s24, 61440
    s_nop 0
    buffer_load_dwordx4 v5, s[12:15], s37 offen lds
    s_add_u32 s37, s37, 128
    ds_read_b128 v[88:91], v18 offset:0
    ds_read_b128 v[92:95], v18 offset:2048
    ds_read_b128 v[96:99], v18 offset:4096
    ds_read_b128 v[100:103], v18 offset:6144
    ds_read_b128 v[104:107], v20 offset:0
    ds_read_b128 v[108:111], v20 offset:2048
    ds_read_b128 v[112:115], v20 offset:4096
    ds_read_b128 v[116:119], v20 offset:6144
    ds_read_b128 v[120:123], v19 offset:0
    ds_read_b128 v[124:127], v19 offset:2048
    ds_read_b128 v[128:131], v19 offset:4096
    ds_read_b128 v[132:135], v19 offset:6144
    ds_read_b128 v[136:139], v21 offset:0
    ds_read_b128 v[140:143], v21 offset:2048
    ds_read_b128 v[144:147], v21 offset:4096
    ds_read_b128 v[148:151], v21 offset:6144
    s_waitcnt lgkmcnt(8)
    v_mfma_f32_16x16x32_bf16 v[24:27], v[88:91], v[104:107], v[24:27]
    v_mfma_f32_16x16x32_bf16 v[28:31], v[88:91], v[108:111], v[28:31]
    v_mfma_f32_16x16x32_bf16 v[32:35], v[88:91], v[112:115], v[32:35]
    v_mfma_f32_16x16x32_bf16 v[36:39], v[88:91], v[116:119], v[36:39]
    v_mfma_f32_16x16x32_bf16 v[40:43], v[92:95], v[104:107], v[40:43]
    v_mfma_f32_16x16x32_bf16 v[44:47], v[92:95], v[108:111], v[44:47]
    v_mfma_f32_16x16x32_bf16 v[48:51], v[92:95], v[112:115], v[48:51]
    v_mfma_f32_16x16x32_bf16 v[52:55], v[92:95], v[116:119], v[52:55]
    v_mfma_f32_16x16x32_bf16 v[56:59], v[96:99], v[104:107], v[56:59]
    v_mfma_f32_16x16x32_bf16 v[60:63], v[96:99], v[108:111], v[60:63]
    v_mfma_f32_16x16x32_bf16 v[64:67], v[96:99], v[112:115], v[64:67]
    v_mfma_f32_16x16x32_bf16 v[68:71], v[96:99], v[116:119], v[68:71]
    v_mfma_f32_16x16x32_bf16 v[72:75], v[100:103], v[104:107], v[72:75]
    v_mfma_f32_16x16x32_bf16 v[76:79], v[100:103], v[108:111], v[76:79]
    v_mfma_f32_16x16x32_bf16 v[80:83], v[100:103], v[112:115], v[80:83]
    v_mfma_f32_16x16x32_bf16 v[84:87], v[100:103], v[116:119], v[84:87]
    s_waitcnt lgkmcnt(0)
    v_mfma_f32_16x16x32_bf16 v[24:27], v[120:123], v[136:139], v[24:27]
    v_mfma_f32_16x16x32_bf16 v[28:31], v[120:123], v[140:143], v[28:31]
    v_mfma_f32_16x16x32_bf16 v[32:35], v[120:123], v[144:147], v[32:35]
    v_mfma_f32_16x16x32_bf16 v[36:39], v[120:123], v[148:151], v[36:39]
    v_mfma_f32_16x16x32_bf16 v[40:43], v[124:127], v[136:139], v[40:43]
    v_mfma_f32_16x16x32_bf16 v[44:47], v[124:127], v[140:143], v[44:47]
    v_mfma_f32_16x16x32_bf16 v[48:51], v[124:127], v[144:147], v[48:51]
    v_mfma_f32_16x16x32_bf16 v[52:55], v[124:127], v[148:151], v[52:55]
    v_mfma_f32_16x16x32_bf16 v[56:59], v[128:131], v[136:139], v[56:59]
    v_mfma_f32_16x16x32_bf16 v[60:63], v[128:131], v[140:143], v[60:63]
    v_mfma_f32_16x16x32_bf16 v[64:67], v[128:131], v[144:147], v[64:67]
    v_mfma_f32_16x16x32_bf16 v[68:71], v[128:131], v[148:151], v[68:71]
    v_mfma_f32_16x16x32_bf16 v[72:75], v[132:135], v[136:139], v[72:75]
    v_mfma_f32_16x16x32_bf16 v[76:79], v[132:135], v[140:143], v[76:79]
    v_mfma_f32_16x16x32_bf16 v[80:83], v[132:135], v[144:147], v[80:83]
    v_mfma_f32_16x16x32_bf16 v[84:87], v[132:135], v[148:151], v[84:87]
    s_waitcnt vmcnt(8)
    s_barrier
    s_add_u32 m0, s24, 65536
    s_nop 0
    buffer_load_dwordx4 v5, s[8:11], s30 offen lds
    s_add_u32 s30, s30, 128
    s_add_u32 m0, s24, 69632
    s_nop 0
    buffer_load_dwordx4 v5, s[8:11], s31 offen lds
    s_add_u32 s31, s31, 128
    s_add_u32 m0, s24, 73728
    s_nop 0
    buffer_load_dwordx4 v5, s[8:11], s32 offen lds
    s_add_u32 s32, s32, 128
    s_add_u32 m0, s24, 77824
    s_nop 0
    buffer_load_dwordx4 v5, s[8:11], s33 offen lds
    s_add_u32 s33, s33, 128
    s_add_u32 m0, s24, 81920
    s_nop 0
    buffer_load_dwordx4 v5, s[12:15], s34 offen lds
    s_add_u32 s34, s34, 128
    s_add_u32 m0, s24, 86016
    s_nop 0
    buffer_load_dwordx4 v5, s[12:15], s35 offen lds
    s_add_u32 s35, s35, 128
    s_add_u32 m0, s24, 90112
    s_nop 0
    buffer_load_dwordx4 v5, s[12:15], s36 offen lds
    s_add_u32 s36, s36, 128
    s_add_u32 m0, s24, 94208
    s_nop 0
    buffer_load_dwordx4 v5, s[12:15], s37 offen lds
    s_add_u32 s37, s37, 128
    ds_read_b128 v[88:91], v10 offset:0
    ds_read_b128 v[92:95], v10 offset:2048
    ds_read_b128 v[96:99], v10 offset:4096
    ds_read_b128 v[100:103], v10 offset:6144
    ds_read_b128 v[104:107], v12 offset:0
    ds_read_b128 v[108:111], v12 offset:2048
    ds_read_b128 v[112:115], v12 offset:4096
    ds_read_b128 v[116:119], v12 offset:6144
    ds_read_b128 v[120:123], v11 offset:0
    ds_read_b128 v[124:127], v11 offset:2048
    ds_read_b128 v[128:131], v11 offset:4096
    ds_read_b128 v[132:135], v11 offset:6144
    ds_read_b128 v[136:139], v13 offset:0
    ds_read_b128 v[140:143], v13 offset:2048
    ds_read_b128 v[144:147], v13 offset:4096
    ds_read_b128 v[148:151], v13 offset:6144
    s_waitcnt lgkmcnt(8)
    v_mfma_f32_16x16x32_bf16 v[24:27], v[88:91], v[104:107], v[24:27]
    v_mfma_f32_16x16x32_bf16 v[28:31], v[88:91], v[108:111], v[28:31]
    v_mfma_f32_16x16x32_bf16 v[32:35], v[88:91], v[112:115], v[32:35]
    v_mfma_f32_16x16x32_bf16 v[36:39], v[88:91], v[116:119], v[36:39]
    v_mfma_f32_16x16x32_bf16 v[40:43], v[92:95], v[104:107], v[40:43]
    v_mfma_f32_16x16x32_bf16 v[44:47], v[92:95], v[108:111], v[44:47]
    v_mfma_f32_16x16x32_bf16 v[48:51], v[92:95], v[112:115], v[48:51]
    v_mfma_f32_16x16x32_bf16 v[52:55], v[92:95], v[116:119], v[52:55]
    v_mfma_f32_16x16x32_bf16 v[56:59], v[96:99], v[104:107], v[56:59]
    v_mfma_f32_16x16x32_bf16 v[60:63], v[96:99], v[108:111], v[60:63]
    v_mfma_f32_16x16x32_bf16 v[64:67], v[96:99], v[112:115], v[64:67]
    v_mfma_f32_16x16x32_bf16 v[68:71], v[96:99], v[116:119], v[68:71]
    v_mfma_f32_16x16x32_bf16 v[72:75], v[100:103], v[104:107], v[72:75]
    v_mfma_f32_16x16x32_bf16 v[76:79], v[100:103], v[108:111], v[76:79]
    v_mfma_f32_16x16x32_bf16 v[80:83], v[100:103], v[112:115], v[80:83]
    v_mfma_f32_16x16x32_bf16 v[84:87], v[100:103], v[116:119], v[84:87]
    s_waitcnt lgkmcnt(0)
    v_mfma_f32_16x16x32_bf16 v[24:27], v[120:123], v[136:139], v[24:27]
    v_mfma_f32_16x16x32_bf16 v[28:31], v[120:123], v[140:143], v[28:31]
    v_mfma_f32_16x16x32_bf16 v[32:35], v[120:123], v[144:147], v[32:35]
    v_mfma_f32_16x16x32_bf16 v[36:39], v[120:123], v[148:151], v[36:39]
    v_mfma_f32_16x16x32_bf16 v[40:43], v[124:127], v[136:139], v[40:43]
    v_mfma_f32_16x16x32_bf16 v[44:47], v[124:127], v[140:143], v[44:47]
    v_mfma_f32_16x16x32_bf16 v[48:51], v[124:127], v[144:147], v[48:51]
    v_mfma_f32_16x16x32_bf16 v[52:55], v[124:127], v[148:151], v[52:55]
    v_mfma_f32_16x16x32_bf16 v[56:59], v[128:131], v[136:139], v[56:59]
    v_mfma_f32_16x16x32_bf16 v[60:63], v[128:131], v[140:143], v[60:63]
    v_mfma_f32_16x16x32_bf16 v[64:67], v[128:131], v[144:147], v[64:67]
    v_mfma_f32_16x16x32_bf16 v[68:71], v[128:131], v[148:151], v[68:71]
    v_mfma_f32_16x16x32_bf16 v[72:75], v[132:135], v[136:139], v[72:75]
    v_mfma_f32_16x16x32_bf16 v[76:79], v[132:135], v[140:143], v[76:79]
    v_mfma_f32_16x16x32_bf16 v[80:83], v[132:135], v[144:147], v[80:83]
    v_mfma_f32_16x16x32_bf16 v[84:87], v[132:135], v[148:151], v[84:87]
    s_waitcnt vmcnt(8)
    s_barrier
    s_add_u32 m0, s24, 0
    s_nop 0
    buffer_load_dwordx4 v5, s[8:11], s30 offen lds
    s_add_u32 s30, s30, 128
    s_add_u32 m0, s24, 4096
    s_nop 0
    buffer_load_dwordx4 v5, s[8:11], s31 offen lds
    s_add_u32 s31, s31, 128
    s_add_u32 m0, s24, 8192
    s_nop 0
    buffer_load_dwordx4 v5, s[8:11], s32 offen lds
    s_add_u32 s32, s32, 128
    s_add_u32 m0, s24, 12288
    s_nop 0
    buffer_load_dwordx4 v5, s[8:11], s33 offen lds
    s_add_u32 s33, s33, 128
    s_add_u32 m0, s24, 16384
    s_nop 0
    buffer_load_dwordx4 v5, s[12:15], s34 offen lds
    s_add_u32 s34, s34, 128
    s_add_u32 m0, s24, 20480
    s_nop 0
    buffer_load_dwordx4 v5, s[12:15], s35 offen lds
    s_add_u32 s35, s35, 128
    s_add_u32 m0, s24, 24576
    s_nop 0
    buffer_load_dwordx4 v5, s[12:15], s36 offen lds
    s_add_u32 s36, s36, 128
    s_add_u32 m0, s24, 28672
    s_nop 0
    buffer_load_dwordx4 v5, s[12:15], s37 offen lds
    s_add_u32 s37, s37, 128
    ds_read_b128 v[88:91], v14 offset:0
    ds_read_b128 v[92:95], v14 offset:2048
    ds_read_b128 v[96:99], v14 offset:4096
    ds_read_b128 v[100:103], v14 offset:6144
    ds_read_b128 v[104:107], v16 offset:0
    ds_read_b128 v[108:111], v16 offset:2048
    ds_read_b128 v[112:115], v16 offset:4096
    ds_read_b128 v[116:119], v16 offset:6144
    ds_read_b128 v[120:123], v15 offset:0
    ds_read_b128 v[124:127], v15 offset:2048
    ds_read_b128 v[128:131], v15 offset:4096
    ds_read_b128 v[132:135], v15 offset:6144
    ds_read_b128 v[136:139], v17 offset:0
    ds_read_b128 v[140:143], v17 offset:2048
    ds_read_b128 v[144:147], v17 offset:4096
    ds_read_b128 v[148:151], v17 offset:6144
    s_waitcnt lgkmcnt(8)
    v_mfma_f32_16x16x32_bf16 v[24:27], v[88:91], v[104:107], v[24:27]
    v_mfma_f32_16x16x32_bf16 v[28:31], v[88:91], v[108:111], v[28:31]
    v_mfma_f32_16x16x32_bf16 v[32:35], v[88:91], v[112:115], v[32:35]
    v_mfma_f32_16x16x32_bf16 v[36:39], v[88:91], v[116:119], v[36:39]
    v_mfma_f32_16x16x32_bf16 v[40:43], v[92:95], v[104:107], v[40:43]
    v_mfma_f32_16x16x32_bf16 v[44:47], v[92:95], v[108:111], v[44:47]
    v_mfma_f32_16x16x32_bf16 v[48:51], v[92:95], v[112:115], v[48:51]
    v_mfma_f32_16x16x32_bf16 v[52:55], v[92:95], v[116:119], v[52:55]
    v_mfma_f32_16x16x32_bf16 v[56:59], v[96:99], v[104:107], v[56:59]
    v_mfma_f32_16x16x32_bf16 v[60:63], v[96:99], v[108:111], v[60:63]
    v_mfma_f32_16x16x32_bf16 v[64:67], v[96:99], v[112:115], v[64:67]
    v_mfma_f32_16x16x32_bf16 v[68:71], v[96:99], v[116:119], v[68:71]
    v_mfma_f32_16x16x32_bf16 v[72:75], v[100:103], v[104:107], v[72:75]
    v_mfma_f32_16x16x32_bf16 v[76:79], v[100:103], v[108:111], v[76:79]
    v_mfma_f32_16x16x32_bf16 v[80:83], v[100:103], v[112:115], v[80:83]
    v_mfma_f32_16x16x32_bf16 v[84:87], v[100:103], v[116:119], v[84:87]
    s_waitcnt lgkmcnt(0)
    v_mfma_f32_16x16x32_bf16 v[24:27], v[120:123], v[136:139], v[24:27]
    v_mfma_f32_16x16x32_bf16 v[28:31], v[120:123], v[140:143], v[28:31]
    v_mfma_f32_16x16x32_bf16 v[32:35], v[120:123], v[144:147], v[32:35]
    v_mfma_f32_16x16x32_bf16 v[36:39], v[120:123], v[148:151], v[36:39]
    v_mfma_f32_16x16x32_bf16 v[40:43], v[124:127], v[136:139], v[40:43]
    v_mfma_f32_16x16x32_bf16 v[44:47], v[124:127], v[140:143], v[44:47]
    v_mfma_f32_16x16x32_bf16 v[48:51], v[124:127], v[144:147], v[48:51]
    v_mfma_f32_16x16x32_bf16 v[52:55], v[124:127], v[148:151], v[52:55]
    v_mfma_f32_16x16x32_bf16 v[56:59], v[128:131], v[136:139], v[56:59]
    v_mfma_f32_16x16x32_bf16 v[60:63], v[128:131], v[140:143], v[60:63]
    v_mfma_f32_16x16x32_bf16 v[64:67], v[128:131], v[144:147], v[64:67]
    v_mfma_f32_16x16x32_bf16 v[68:71], v[128:131], v[148:151], v[68:71]
    v_mfma_f32_16x16x32_bf16 v[72:75], v[132:135], v[136:139], v[72:75]
    v_mfma_f32_16x16x32_bf16 v[76:79], v[132:135], v[140:143], v[76:79]
    v_mfma_f32_16x16x32_bf16 v[80:83], v[132:135], v[144:147], v[80:83]
    v_mfma_f32_16x16x32_bf16 v[84:87], v[132:135], v[148:151], v[84:87]
    s_waitcnt vmcnt(8)
    s_barrier
    ds_read_b128 v[88:91], v18 offset:0
    ds_read_b128 v[92:95], v18 offset:2048
    ds_read_b128 v[96:99], v18 offset:4096
    ds_read_b128 v[100:103], v18 offset:6144
    ds_read_b128 v[104:107], v20 offset:0
    ds_read_b128 v[108:111], v20 offset:2048
    ds_read_b128 v[112:115], v20 offset:4096
    ds_read_b128 v[116:119], v20 offset:6144
    ds_read_b128 v[120:123], v19 offset:0
    ds_read_b128 v[124:127], v19 offset:2048
    ds_read_b128 v[128:131], v19 offset:4096
    ds_read_b128 v[132:135], v19 offset:6144
    ds_read_b128 v[136:139], v21 offset:0
    ds_read_b128 v[140:143], v21 offset:2048
    ds_read_b128 v[144:147], v21 offset:4096
    ds_read_b128 v[148:151], v21 offset:6144
    s_waitcnt lgkmcnt(8)
    v_mfma_f32_16x16x32_bf16 v[24:27], v[88:91], v[104:107], v[24:27]
    v_mfma_f32_16x16x32_bf16 v[28:31], v[88:91], v[108:111], v[28:31]
    v_mfma_f32_16x16x32_bf16 v[32:35], v[88:91], v[112:115], v[32:35]
    v_mfma_f32_16x16x32_bf16 v[36:39], v[88:91], v[116:119], v[36:39]
    v_mfma_f32_16x16x32_bf16 v[40:43], v[92:95], v[104:107], v[40:43]
    v_mfma_f32_16x16x32_bf16 v[44:47], v[92:95], v[108:111], v[44:47]
    v_mfma_f32_16x16x32_bf16 v[48:51], v[92:95], v[112:115], v[48:51]
    v_mfma_f32_16x16x32_bf16 v[52:55], v[92:95], v[116:119], v[52:55]
    v_mfma_f32_16x16x32_bf16 v[56:59], v[96:99], v[104:107], v[56:59]
    v_mfma_f32_16x16x32_bf16 v[60:63], v[96:99], v[108:111], v[60:63]
    v_mfma_f32_16x16x32_bf16 v[64:67], v[96:99], v[112:115], v[64:67]
    v_mfma_f32_16x16x32_bf16 v[68:71], v[96:99], v[116:119], v[68:71]
    v_mfma_f32_16x16x32_bf16 v[72:75], v[100:103], v[104:107], v[72:75]
    v_mfma_f32_16x16x32_bf16 v[76:79], v[100:103], v[108:111], v[76:79]
    v_mfma_f32_16x16x32_bf16 v[80:83], v[100:103], v[112:115], v[80:83]
    v_mfma_f32_16x16x32_bf16 v[84:87], v[100:103], v[116:119], v[84:87]
    s_waitcnt lgkmcnt(0)
    v_mfma_f32_16x16x32_bf16 v[24:27], v[120:123], v[136:139], v[24:27]
    v_mfma_f32_16x16x32_bf16 v[28:31], v[120:123], v[140:143], v[28:31]
    v_mfma_f32_16x16x32_bf16 v[32:35], v[120:123], v[144:147], v[32:35]
    v_mfma_f32_16x16x32_bf16 v[36:39], v[120:123], v[148:151], v[36:39]
    v_mfma_f32_16x16x32_bf16 v[40:43], v[124:127], v[136:139], v[40:43]
    v_mfma_f32_16x16x32_bf16 v[44:47], v[124:127], v[140:143], v[44:47]
    v_mfma_f32_16x16x32_bf16 v[48:51], v[124:127], v[144:147], v[48:51]
    v_mfma_f32_16x16x32_bf16 v[52:55], v[124:127], v[148:151], v[52:55]
    v_mfma_f32_16x16x32_bf16 v[56:59], v[128:131], v[136:139], v[56:59]
    v_mfma_f32_16x16x32_bf16 v[60:63], v[128:131], v[140:143], v[60:63]
    v_mfma_f32_16x16x32_bf16 v[64:67], v[128:131], v[144:147], v[64:67]
    v_mfma_f32_16x16x32_bf16 v[68:71], v[128:131], v[148:151], v[68:71]
    v_mfma_f32_16x16x32_bf16 v[72:75], v[132:135], v[136:139], v[72:75]
    v_mfma_f32_16x16x32_bf16 v[76:79], v[132:135], v[140:143], v[76:79]
    v_mfma_f32_16x16x32_bf16 v[80:83], v[132:135], v[144:147], v[80:83]
    v_mfma_f32_16x16x32_bf16 v[84:87], v[132:135], v[148:151], v[84:87]
    s_waitcnt vmcnt(0)
    s_barrier
    ds_read_b128 v[88:91], v10 offset:0
    ds_read_b128 v[92:95], v10 offset:2048
    ds_read_b128 v[96:99], v10 offset:4096
    ds_read_b128 v[100:103], v10 offset:6144
    ds_read_b128 v[104:107], v12 offset:0
    ds_read_b128 v[108:111], v12 offset:2048
    ds_read_b128 v[112:115], v12 offset:4096
    ds_read_b128 v[116:119], v12 offset:6144
    ds_read_b128 v[120:123], v11 offset:0
    ds_read_b128 v[124:127], v11 offset:2048
    ds_read_b128 v[128:131], v11 offset:4096
    ds_read_b128 v[132:135], v11 offset:6144
    ds_read_b128 v[136:139], v13 offset:0
    ds_read_b128 v[140:143], v13 offset:2048
    ds_read_b128 v[144:147], v13 offset:4096
    ds_read_b128 v[148:151], v13 offset:6144
    s_waitcnt lgkmcnt(8)
    v_mfma_f32_16x16x32_bf16 v[24:27], v[88:91], v[104:107], v[24:27]
    v_mfma_f32_16x16x32_bf16 v[28:31], v[88:91], v[108:111], v[28:31]
    v_mfma_f32_16x16x32_bf16 v[32:35], v[88:91], v[112:115], v[32:35]
    v_mfma_f32_16x16x32_bf16 v[36:39], v[88:91], v[116:119], v[36:39]
    v_mfma_f32_16x16x32_bf16 v[40:43], v[92:95], v[104:107], v[40:43]
    v_mfma_f32_16x16x32_bf16 v[44:47], v[92:95], v[108:111], v[44:47]
    v_mfma_f32_16x16x32_bf16 v[48:51], v[92:95], v[112:115], v[48:51]
    v_mfma_f32_16x16x32_bf16 v[52:55], v[92:95], v[116:119], v[52:55]
    v_mfma_f32_16x16x32_bf16 v[56:59], v[96:99], v[104:107], v[56:59]
    v_mfma_f32_16x16x32_bf16 v[60:63], v[96:99], v[108:111], v[60:63]
    v_mfma_f32_16x16x32_bf16 v[64:67], v[96:99], v[112:115], v[64:67]
    v_mfma_f32_16x16x32_bf16 v[68:71], v[96:99], v[116:119], v[68:71]
    v_mfma_f32_16x16x32_bf16 v[72:75], v[100:103], v[104:107], v[72:75]
    v_mfma_f32_16x16x32_bf16 v[76:79], v[100:103], v[108:111], v[76:79]
    v_mfma_f32_16x16x32_bf16 v[80:83], v[100:103], v[112:115], v[80:83]
    v_mfma_f32_16x16x32_bf16 v[84:87], v[100:103], v[116:119], v[84:87]
    s_waitcnt lgkmcnt(0)
    v_mfma_f32_16x16x32_bf16 v[24:27], v[120:123], v[136:139], v[24:27]
    v_mfma_f32_16x16x32_bf16 v[28:31], v[120:123], v[140:143], v[28:31]
    v_mfma_f32_16x16x32_bf16 v[32:35], v[120:123], v[144:147], v[32:35]
    v_mfma_f32_16x16x32_bf16 v[36:39], v[120:123], v[148:151], v[36:39]
    v_mfma_f32_16x16x32_bf16 v[40:43], v[124:127], v[136:139], v[40:43]
    v_mfma_f32_16x16x32_bf16 v[44:47], v[124:127], v[140:143], v[44:47]
    v_mfma_f32_16x16x32_bf16 v[48:51], v[124:127], v[144:147], v[48:51]
    v_mfma_f32_16x16x32_bf16 v[52:55], v[124:127], v[148:151], v[52:55]
    v_mfma_f32_16x16x32_bf16 v[56:59], v[128:131], v[136:139], v[56:59]
    v_mfma_f32_16x16x32_bf16 v[60:63], v[128:131], v[140:143], v[60:63]
    v_mfma_f32_16x16x32_bf16 v[64:67], v[128:131], v[144:147], v[64:67]
    v_mfma_f32_16x16x32_bf16 v[68:71], v[128:131], v[148:151], v[68:71]
    v_mfma_f32_16x16x32_bf16 v[72:75], v[132:135], v[136:139], v[72:75]
    v_mfma_f32_16x16x32_bf16 v[76:79], v[132:135], v[140:143], v[76:79]
    v_mfma_f32_16x16x32_bf16 v[80:83], v[132:135], v[144:147], v[80:83]
    v_mfma_f32_16x16x32_bf16 v[84:87], v[132:135], v[148:151], v[84:87]
    s_nop 7
    s_nop 7
    v_lshlrev_b32 v6, 12, v6
    v_lshl_add_u32 v6, v7, 3, v6
    s_lshl_b32 s27, s51, 19
    s_lshl_b32 s28, s26, 18
    s_add_u32 s27, s27, s28
    s_lshl_b32 s28, s50, 8
    s_add_u32 s27, s27, s28
    s_lshl_b32 s28, s25, 7
    s_add_u32 s27, s27, s28
    v_add_u32 v6, s27, v6
    v_add_u32 v4, 0, v6
    v_cvt_pk_bf16_f32 v2, v24, v25
    v_cvt_pk_bf16_f32 v3, v26, v27
    buffer_store_dwordx2 v[2:3], v4, s[16:19], 0 offen offset:0
    s_nop 1
    v_cvt_pk_bf16_f32 v2, v40, v41
    v_cvt_pk_bf16_f32 v3, v42, v43
    buffer_store_dwordx2 v[2:3], v4, s[16:19], 0 offen offset:32
    s_nop 1
    v_cvt_pk_bf16_f32 v2, v56, v57
    v_cvt_pk_bf16_f32 v3, v58, v59
    buffer_store_dwordx2 v[2:3], v4, s[16:19], 0 offen offset:64
    s_nop 1
    v_cvt_pk_bf16_f32 v2, v72, v73
    v_cvt_pk_bf16_f32 v3, v74, v75
    buffer_store_dwordx2 v[2:3], v4, s[16:19], 0 offen offset:96
    s_nop 1
    v_add_u32 v4, 65536, v6
    v_cvt_pk_bf16_f32 v2, v28, v29
    v_cvt_pk_bf16_f32 v3, v30, v31
    buffer_store_dwordx2 v[2:3], v4, s[16:19], 0 offen offset:0
    s_nop 1
    v_cvt_pk_bf16_f32 v2, v44, v45
    v_cvt_pk_bf16_f32 v3, v46, v47
    buffer_store_dwordx2 v[2:3], v4, s[16:19], 0 offen offset:32
    s_nop 1
    v_cvt_pk_bf16_f32 v2, v60, v61
    v_cvt_pk_bf16_f32 v3, v62, v63
    buffer_store_dwordx2 v[2:3], v4, s[16:19], 0 offen offset:64
    s_nop 1
    v_cvt_pk_bf16_f32 v2, v76, v77
    v_cvt_pk_bf16_f32 v3, v78, v79
    buffer_store_dwordx2 v[2:3], v4, s[16:19], 0 offen offset:96
    s_nop 1
    v_add_u32 v4, 131072, v6
    v_cvt_pk_bf16_f32 v2, v32, v33
    v_cvt_pk_bf16_f32 v3, v34, v35
    buffer_store_dwordx2 v[2:3], v4, s[16:19], 0 offen offset:0
    s_nop 1
    v_cvt_pk_bf16_f32 v2, v48, v49
    v_cvt_pk_bf16_f32 v3, v50, v51
    buffer_store_dwordx2 v[2:3], v4, s[16:19], 0 offen offset:32
    s_nop 1
    v_cvt_pk_bf16_f32 v2, v64, v65
    v_cvt_pk_bf16_f32 v3, v66, v67
    buffer_store_dwordx2 v[2:3], v4, s[16:19], 0 offen offset:64
    s_nop 1
    v_cvt_pk_bf16_f32 v2, v80, v81
    v_cvt_pk_bf16_f32 v3, v82, v83
    buffer_store_dwordx2 v[2:3], v4, s[16:19], 0 offen offset:96
    s_nop 1
    v_add_u32 v4, 196608, v6
    v_cvt_pk_bf16_f32 v2, v36, v37
    v_cvt_pk_bf16_f32 v3, v38, v39
    buffer_store_dwordx2 v[2:3], v4, s[16:19], 0 offen offset:0
    s_nop 1
    v_cvt_pk_bf16_f32 v2, v52, v53
    v_cvt_pk_bf16_f32 v3, v54, v55
    buffer_store_dwordx2 v[2:3], v4, s[16:19], 0 offen offset:32
    s_nop 1
    v_cvt_pk_bf16_f32 v2, v68, v69
    v_cvt_pk_bf16_f32 v3, v70, v71
    buffer_store_dwordx2 v[2:3], v4, s[16:19], 0 offen offset:64
    s_nop 1
    v_cvt_pk_bf16_f32 v2, v84, v85
    v_cvt_pk_bf16_f32 v3, v86, v87
    buffer_store_dwordx2 v[2:3], v4, s[16:19], 0 offen offset:96
    s_nop 1
L_k1_end:
    s_endpgm
.globl k2_kernel
.p2align 8
.type k2_kernel,@function
k2_kernel:
    s_cmp_ge_u32 s2, 256
    s_cbranch_scc1 L_k2_end
    s_load_dwordx4 s[44:47], s[0:1], 56
    s_load_dwordx2 s[48:49], s[0:1], 104
    s_and_b32 s3, s2, 7
    s_lshr_b32 s50, s2, 3
    s_lshr_b32 s51, s3, 1
    s_and_b32 s3, s3, 1
    s_lshl_b32 s3, s3, 3
    s_lshr_b32 s52, s50, 2
    s_add_u32 s52, s52, s3
    s_and_b32 s53, s50, 3
    s_waitcnt lgkmcnt(0)
    s_cmp_ge_u32 s51, 2
    s_cselect_b32 s44, s46, s44
    s_cselect_b32 s45, s47, s45
    s_cselect_b32 s54, 2621440, 0
    s_mov_b32 s8, s48
    s_mov_b32 s9, s49
    s_mov_b32 s10, 5242880
    s_mov_b32 s11, 0x00020000
    s_mov_b32 s12, s44
    s_mov_b32 s13, s45
    s_mov_b32 s14, 8388608
    s_mov_b32 s15, 0x00020000
    s_add_u32 s16, s48, 8388608
    s_addc_u32 s17, s49, 0
    s_mov_b32 s18, 20971520
    s_mov_b32 s19, 0x00020000
    s_and_b32 s55, s51, 1
    s_lshl_b32 s55, s55, 11
    s_mul_i32 s20, s53, 655360
    s_add_u32 s20, s20, s54
    s_add_u32 s20, s20, s55
    s_mul_i32 s21, s52, 524288
    s_add_u32 s21, s21, s55
    v_lshrrev_b32 v1, 6, v0
    s_nop 1
    v_readfirstlane_b32 s22, v1
    v_and_b32 v2, 63, v0
    v_lshrrev_b32 v3, 3, v2
    v_and_b32 v4, 7, v2
    v_xor_b32 v4, v4, v3
    s_mov_b32 s23, 4096
    v_mul_lo_u32 v5, v3, s23
    v_lshl_add_u32 v5, v4, 4, v5
    s_add_u32 s30, s22, 0
    s_mul_i32 s30, s30, 32768
    s_add_u32 s30, s30, s20
    s_add_u32 s31, s22, 4
    s_mul_i32 s31, s31, 32768
    s_add_u32 s31, s31, s20
    s_add_u32 s32, s22, 8
    s_mul_i32 s32, s32, 32768
    s_add_u32 s32, s32, s20
    s_add_u32 s33, s22, 12
    s_mul_i32 s33, s33, 32768
    s_add_u32 s33, s33, s20
    s_add_u32 s34, s22, 16
    s_mul_i32 s34, s34, 32768
    s_add_u32 s34, s34, s20
    s_add_u32 s35, s22, 0
    s_mul_i32 s35, s35, 32768
    s_add_u32 s35, s35, s21
    s_add_u32 s36, s22, 4
    s_mul_i32 s36, s36, 32768
    s_add_u32 s36, s36, s21
    s_add_u32 s37, s22, 8
    s_mul_i32 s37, s37, 32768
    s_add_u32 s37, s37, s21
    s_add_u32 s38, s22, 12
    s_mul_i32 s38, s38, 32768
    s_add_u32 s38, s38, s21
    s_lshl_b32 s24, s22, 10
    v_and_b32 v6, 15, v2
    v_lshrrev_b32 v7, 4, v2
    v_and_b32 v8, 7, v2
    v_xor_b32 v8, v8, v7
    v_lshlrev_b32 v8, 4, v8
    v_lshl_add_u32 v8, v6, 7, v8
    s_lshr_b32 s25, s22, 1
    s_and_b32 s26, s22, 1
    s_mul_i32 s27, s25, 10240
    s_mul_i32 s28, s26, 8192
    s_add_u32 s28, s28, 20480
    s_add_u32 s29, s27, 0
    v_add_u32 v10, s29, v8
    v_xor_b32 v11, 64, v10
    s_add_u32 s29, s28, 0
    v_add_u32 v12, s29, v8
    v_xor_b32 v13, 64, v12
    s_add_u32 s29, s27, 36864
    v_add_u32 v14, s29, v8
    v_xor_b32 v15, 64, v14
    s_add_u32 s29, s28, 36864
    v_add_u32 v16, s29, v8
    v_xor_b32 v17, 64, v16
    s_add_u32 s29, s27, 73728
    v_add_u32 v18, s29, v8
    v_xor_b32 v19, 64, v18
    s_add_u32 s29, s28, 73728
    v_add_u32 v20, s29, v8
    v_xor_b32 v21, 64, v20
    v_mov_b32 v24, 0
    v_mov_b32 v25, 0
    v_mov_b32 v26, 0
    v_mov_b32 v27, 0
    v_mov_b32 v28, 0
    v_mov_b32 v29, 0
    v_mov_b32 v30, 0
    v_mov_b32 v31, 0
    v_mov_b32 v32, 0
    v_mov_b32 v33, 0
    v_mov_b32 v34, 0
    v_mov_b32 v35, 0
    v_mov_b32 v36, 0
    v_mov_b32 v37, 0
    v_mov_b32 v38, 0
    v_mov_b32 v39, 0
    v_mov_b32 v40, 0
    v_mov_b32 v41, 0
    v_mov_b32 v42, 0
    v_mov_b32 v43, 0
    v_mov_b32 v44, 0
    v_mov_b32 v45, 0
    v_mov_b32 v46, 0
    v_mov_b32 v47, 0
    v_mov_b32 v48, 0
    v_mov_b32 v49, 0
    v_mov_b32 v50, 0
    v_mov_b32 v51, 0
    v_mov_b32 v52, 0
    v_mov_b32 v53, 0
    v_mov_b32 v54, 0
    v_mov_b32 v55, 0
    v_mov_b32 v56, 0
    v_mov_b32 v57, 0
    v_mov_b32 v58, 0
    v_mov_b32 v59, 0
    v_mov_b32 v60, 0
    v_mov_b32 v61, 0
    v_mov_b32 v62, 0
    v_mov_b32 v63, 0
    v_mov_b32 v64, 0
    v_mov_b32 v65, 0
    v_mov_b32 v66, 0
    v_mov_b32 v67, 0
    v_mov_b32 v68, 0
    v_mov_b32 v69, 0
    v_mov_b32 v70, 0
    v_mov_b32 v71, 0
    v_mov_b32 v72, 0
    v_mov_b32 v73, 0
    v_mov_b32 v74, 0
    v_mov_b32 v75, 0
    v_mov_b32 v76, 0
    v_mov_b32 v77, 0
    v_mov_b32 v78, 0
    v_mov_b32 v79, 0
    v_mov_b32 v80, 0
    v_mov_b32 v81, 0
    v_mov_b32 v82, 0
    v_mov_b32 v83, 0
    v_mov_b32 v84, 0
    v_mov_b32 v85, 0
    v_mov_b32 v86, 0
    v_mov_b32 v87, 0
    v_mov_b32 v88, 0
    v_mov_b32 v89, 0
    v_mov_b32 v90, 0
    v_mov_b32 v91, 0
    v_mov_b32 v92, 0
    v_mov_b32 v93, 0
    v_mov_b32 v94, 0
    v_mov_b32 v95, 0
    v_mov_b32 v96, 0
    v_mov_b32 v97, 0
    v_mov_b32 v98, 0
    v_mov_b32 v99, 0
    v_mov_b32 v100, 0
    v_mov_b32 v101, 0
    v_mov_b32 v102, 0
    v_mov_b32 v103, 0
    s_add_u32 m0, s24, 0
    s_nop 0
    buffer_load_dwordx4 v5, s[8:11], s30 offen lds
    s_add_u32 s30, s30, 128
    s_add_u32 m0, s24, 4096
    s_nop 0
    buffer_load_dwordx4 v5, s[8:11], s31 offen lds
    s_add_u32 s31, s31, 128
    s_add_u32 m0, s24, 8192
    s_nop 0
    buffer_load_dwordx4 v5, s[8:11], s32 offen lds
    s_add_u32 s32, s32, 128
    s_add_u32 m0, s24, 12288
    s_nop 0
    buffer_load_dwordx4 v5, s[8:11], s33 offen lds
    s_add_u32 s33, s33, 128
    s_add_u32 m0, s24, 16384
    s_nop 0
    buffer_load_dwordx4 v5, s[8:11], s34 offen lds
    s_add_u32 s34, s34, 128
    s_add_u32 m0, s24, 20480
    s_nop 0
    buffer_load_dwordx4 v5, s[12:15], s35 offen lds
    s_add_u32 s35, s35, 128
    s_add_u32 m0, s24, 24576
    s_nop 0
    buffer_load_dwordx4 v5, s[12:15], s36 offen lds
    s_add_u32 s36, s36, 128
    s_add_u32 m0, s24, 28672
    s_nop 0
    buffer_load_dwordx4 v5, s[12:15], s37 offen lds
    s_add_u32 s37, s37, 128
    s_add_u32 m0, s24, 32768
    s_nop 0
    buffer_load_dwordx4 v5, s[12:15], s38 offen lds
    s_add_u32 s38, s38, 128
    s_add_u32 m0, s24, 36864
    s_nop 0
    buffer_load_dwordx4 v5, s[8:11], s30 offen lds
    s_add_u32 s30, s30, 128
    s_add_u32 m0, s24, 40960
    s_nop 0
    buffer_load_dwordx4 v5, s[8:11], s31 offen lds
    s_add_u32 s31, s31, 128
    s_add_u32 m0, s24, 45056
    s_nop 0
    buffer_load_dwordx4 v5, s[8:11], s32 offen lds
    s_add_u32 s32, s32, 128
    s_add_u32 m0, s24, 49152
    s_nop 0
    buffer_load_dwordx4 v5, s[8:11], s33 offen lds
    s_add_u32 s33, s33, 128
    s_add_u32 m0, s24, 53248
    s_nop 0
    buffer_load_dwordx4 v5, s[8:11], s34 offen lds
    s_add_u32 s34, s34, 128
    s_add_u32 m0, s24, 57344
    s_nop 0
    buffer_load_dwordx4 v5, s[12:15], s35 offen lds
    s_add_u32 s35, s35, 128
    s_add_u32 m0, s24, 61440
    s_nop 0
    buffer_load_dwordx4 v5, s[12:15], s36 offen lds
    s_add_u32 s36, s36, 128
    s_add_u32 m0, s24, 65536
    s_nop 0
    buffer_load_dwordx4 v5, s[12:15], s37 offen lds
    s_add_u32 s37, s37, 128
    s_add_u32 m0, s24, 69632
    s_nop 0
    buffer_load_dwordx4 v5, s[12:15], s38 offen lds
    s_add_u32 s38, s38, 128
    s_waitcnt vmcnt(9)
    s_barrier
    s_add_u32 m0, s24, 73728
    s_nop 0
    buffer_load_dwordx4 v5, s[8:11], s30 offen lds
    s_add_u32 s30, s30, 128
    s_add_u32 m0, s24, 77824
    s_nop 0
    buffer_load_dwordx4 v5, s[8:11], s31 offen lds
    s_add_u32 s31, s31, 128
    s_add_u32 m0, s24, 81920
    s_nop 0
    buffer_load_dwordx4 v5, s[8:11], s32 offen lds
    s_add_u32 s32, s32, 128
    s_add_u32 m0, s24, 86016
    s_nop 0
    buffer_load_dwordx4 v5, s[8:11], s33 offen lds
    s_add_u32 s33, s33, 128
    s_add_u32 m0, s24, 90112
    s_nop 0
    buffer_load_dwordx4 v5, s[8:11], s34 offen lds
    s_add_u32 s34, s34, 128
    s_add_u32 m0, s24, 94208
    s_nop 0
    buffer_load_dwordx4 v5, s[12:15], s35 offen lds
    s_add_u32 s35, s35, 128
    s_add_u32 m0, s24, 98304
    s_nop 0
    buffer_load_dwordx4 v5, s[12:15], s36 offen lds
    s_add_u32 s36, s36, 128
    s_add_u32 m0, s24, 102400
    s_nop 0
    buffer_load_dwordx4 v5, s[12:15], s37 offen lds
    s_add_u32 s37, s37, 128
    s_add_u32 m0, s24, 106496
    s_nop 0
    buffer_load_dwordx4 v5, s[12:15], s38 offen lds
    s_add_u32 s38, s38, 128
    ds_read_b128 v[104:107], v10 offset:0
    ds_read_b128 v[108:111], v10 offset:2048
    ds_read_b128 v[112:115], v10 offset:4096
    ds_read_b128 v[116:119], v10 offset:6144
    ds_read_b128 v[120:123], v10 offset:8192
    ds_read_b128 v[124:127], v12 offset:0
    ds_read_b128 v[128:131], v12 offset:2048
    ds_read_b128 v[132:135], v12 offset:4096
    ds_read_b128 v[136:139], v12 offset:6144
    ds_read_b128 v[140:143], v11 offset:0
    ds_read_b128 v[144:147], v11 offset:2048
    ds_read_b128 v[148:151], v11 offset:4096
    ds_read_b128 v[152:155], v11 offset:6144
    ds_read_b128 v[156:159], v11 offset:8192
    ds_read_b128 v[160:163], v13 offset:0
    ds_read_b128 v[164:167], v13 offset:2048
    ds_read_b128 v[168:171], v13 offset:4096
    ds_read_b128 v[172:175], v13 offset:6144
    s_waitcnt lgkmcnt(9)
    v_mfma_f32_16x16x32_bf16 v[24:27], v[104:107], v[124:127], v[24:27]
    v_mfma_f32_16x16x32_bf16 v[28:31], v[104:107], v[128:131], v[28:31]
    v_mfma_f32_16x16x32_bf16 v[32:35], v[104:107], v[132:135], v[32:35]
    v_mfma_f32_16x16x32_bf16 v[36:39], v[104:107], v[136:139], v[36:39]
    v_mfma_f32_16x16x32_bf16 v[40:43], v[108:111], v[124:127], v[40:43]
    v_mfma_f32_16x16x32_bf16 v[44:47], v[108:111], v[128:131], v[44:47]
    v_mfma_f32_16x16x32_bf16 v[48:51], v[108:111], v[132:135], v[48:51]
    v_mfma_f32_16x16x32_bf16 v[52:55], v[108:111], v[136:139], v[52:55]
    v_mfma_f32_16x16x32_bf16 v[56:59], v[112:115], v[124:127], v[56:59]
    v_mfma_f32_16x16x32_bf16 v[60:63], v[112:115], v[128:131], v[60:63]
    v_mfma_f32_16x16x32_bf16 v[64:67], v[112:115], v[132:135], v[64:67]
    v_mfma_f32_16x16x32_bf16 v[68:71], v[112:115], v[136:139], v[68:71]
    v_mfma_f32_16x16x32_bf16 v[72:75], v[116:119], v[124:127], v[72:75]
    v_mfma_f32_16x16x32_bf16 v[76:79], v[116:119], v[128:131], v[76:79]
    v_mfma_f32_16x16x32_bf16 v[80:83], v[116:119], v[132:135], v[80:83]
    v_mfma_f32_16x16x32_bf16 v[84:87], v[116:119], v[136:139], v[84:87]
    v_mfma_f32_16x16x32_bf16 v[88:91], v[120:123], v[124:127], v[88:91]
    v_mfma_f32_16x16x32_bf16 v[92:95], v[120:123], v[128:131], v[92:95]
    v_mfma_f32_16x16x32_bf16 v[96:99], v[120:123], v[132:135], v[96:99]
    v_mfma_f32_16x16x32_bf16 v[100:103], v[120:123], v[136:139], v[100:103]
    s_waitcnt lgkmcnt(0)
    v_mfma_f32_16x16x32_bf16 v[24:27], v[140:143], v[160:163], v[24:27]
    v_mfma_f32_16x16x32_bf16 v[28:31], v[140:143], v[164:167], v[28:31]
    v_mfma_f32_16x16x32_bf16 v[32:35], v[140:143], v[168:171], v[32:35]
    v_mfma_f32_16x16x32_bf16 v[36:39], v[140:143], v[172:175], v[36:39]
    v_mfma_f32_16x16x32_bf16 v[40:43], v[144:147], v[160:163], v[40:43]
    v_mfma_f32_16x16x32_bf16 v[44:47], v[144:147], v[164:167], v[44:47]
    v_mfma_f32_16x16x32_bf16 v[48:51], v[144:147], v[168:171], v[48:51]
    v_mfma_f32_16x16x32_bf16 v[52:55], v[144:147], v[172:175], v[52:55]
    v_mfma_f32_16x16x32_bf16 v[56:59], v[148:151], v[160:163], v[56:59]
    v_mfma_f32_16x16x32_bf16 v[60:63], v[148:151], v[164:167], v[60:63]
    v_mfma_f32_16x16x32_bf16 v[64:67], v[148:151], v[168:171], v[64:67]
    v_mfma_f32_16x16x32_bf16 v[68:71], v[148:151], v[172:175], v[68:71]
    v_mfma_f32_16x16x32_bf16 v[72:75], v[152:155], v[160:163], v[72:75]
    v_mfma_f32_16x16x32_bf16 v[76:79], v[152:155], v[164:167], v[76:79]
    v_mfma_f32_16x16x32_bf16 v[80:83], v[152:155], v[168:171], v[80:83]
    v_mfma_f32_16x16x32_bf16 v[84:87], v[152:155], v[172:175], v[84:87]
    v_mfma_f32_16x16x32_bf16 v[88:91], v[156:159], v[160:163], v[88:91]
    v_mfma_f32_16x16x32_bf16 v[92:95], v[156:159], v[164:167], v[92:95]
    v_mfma_f32_16x16x32_bf16 v[96:99], v[156:159], v[168:171], v[96:99]
    v_mfma_f32_16x16x32_bf16 v[100:103], v[156:159], v[172:175], v[100:103]
    s_waitcnt vmcnt(9)
    s_barrier
    s_add_u32 m0, s24, 0
    s_nop 0
    buffer_load_dwordx4 v5, s[8:11], s30 offen lds
    s_add_u32 s30, s30, 128
    s_add_u32 m0, s24, 4096
    s_nop 0
    buffer_load_dwordx4 v5, s[8:11], s31 offen lds
    s_add_u32 s31, s31, 128
    s_add_u32 m0, s24, 8192
    s_nop 0
    buffer_load_dwordx4 v5, s[8:11], s32 offen lds
    s_add_u32 s32, s32, 128
    s_add_u32 m0, s24, 12288
    s_nop 0
    buffer_load_dwordx4 v5, s[8:11], s33 offen lds
    s_add_u32 s33, s33, 128
    s_add_u32 m0, s24, 16384
    s_nop 0
    buffer_load_dwordx4 v5, s[8:11], s34 offen lds
    s_add_u32 s34, s34, 128
    s_add_u32 m0, s24, 20480
    s_nop 0
    buffer_load_dwordx4 v5, s[12:15], s35 offen lds
    s_add_u32 s35, s35, 128
    s_add_u32 m0, s24, 24576
    s_nop 0
    buffer_load_dwordx4 v5, s[12:15], s36 offen lds
    s_add_u32 s36, s36, 128
    s_add_u32 m0, s24, 28672
    s_nop 0
    buffer_load_dwordx4 v5, s[12:15], s37 offen lds
    s_add_u32 s37, s37, 128
    s_add_u32 m0, s24, 32768
    s_nop 0
    buffer_load_dwordx4 v5, s[12:15], s38 offen lds
    s_add_u32 s38, s38, 128
    ds_read_b128 v[104:107], v14 offset:0
    ds_read_b128 v[108:111], v14 offset:2048
    ds_read_b128 v[112:115], v14 offset:4096
    ds_read_b128 v[116:119], v14 offset:6144
    ds_read_b128 v[120:123], v14 offset:8192
    ds_read_b128 v[124:127], v16 offset:0
    ds_read_b128 v[128:131], v16 offset:2048
    ds_read_b128 v[132:135], v16 offset:4096
    ds_read_b128 v[136:139], v16 offset:6144
    ds_read_b128 v[140:143], v15 offset:0
    ds_read_b128 v[144:147], v15 offset:2048
    ds_read_b128 v[148:151], v15 offset:4096
    ds_read_b128 v[152:155], v15 offset:6144
    ds_read_b128 v[156:159], v15 offset:8192
    ds_read_b128 v[160:163], v17 offset:0
    ds_read_b128 v[164:167], v17 offset:2048
    ds_read_b128 v[168:171], v17 offset:4096
    ds_read_b128 v[172:175], v17 offset:6144
    s_waitcnt lgkmcnt(9)
    v_mfma_f32_16x16x32_bf16 v[24:27], v[104:107], v[124:127], v[24:27]
    v_mfma_f32_16x16x32_bf16 v[28:31], v[104:107], v[128:131], v[28:31]
    v_mfma_f32_16x16x32_bf16 v[32:35], v[104:107], v[132:135], v[32:35]
    v_mfma_f32_16x16x32_bf16 v[36:39], v[104:107], v[136:139], v[36:39]
    v_mfma_f32_16x16x32_bf16 v[40:43], v[108:111], v[124:127], v[40:43]
    v_mfma_f32_16x16x32_bf16 v[44:47], v[108:111], v[128:131], v[44:47]
    v_mfma_f32_16x16x32_bf16 v[48:51], v[108:111], v[132:135], v[48:51]
    v_mfma_f32_16x16x32_bf16 v[52:55], v[108:111], v[136:139], v[52:55]
    v_mfma_f32_16x16x32_bf16 v[56:59], v[112:115], v[124:127], v[56:59]
    v_mfma_f32_16x16x32_bf16 v[60:63], v[112:115], v[128:131], v[60:63]
    v_mfma_f32_16x16x32_bf16 v[64:67], v[112:115], v[132:135], v[64:67]
    v_mfma_f32_16x16x32_bf16 v[68:71], v[112:115], v[136:139], v[68:71]
    v_mfma_f32_16x16x32_bf16 v[72:75], v[116:119], v[124:127], v[72:75]
    v_mfma_f32_16x16x32_bf16 v[76:79], v[116:119], v[128:131], v[76:79]
    v_mfma_f32_16x16x32_bf16 v[80:83], v[116:119], v[132:135], v[80:83]
    v_mfma_f32_16x16x32_bf16 v[84:87], v[116:119], v[136:139], v[84:87]
    v_mfma_f32_16x16x32_bf16 v[88:91], v[120:123], v[124:127], v[88:91]
    v_mfma_f32_16x16x32_bf16 v[92:95], v[120:123], v[128:131], v[92:95]
    v_mfma_f32_16x16x32_bf16 v[96:99], v[120:123], v[132:135], v[96:99]
    v_mfma_f32_16x16x32_bf16 v[100:103], v[120:123], v[136:139], v[100:103]
    s_waitcnt lgkmcnt(0)
    v_mfma_f32_16x16x32_bf16 v[24:27], v[140:143], v[160:163], v[24:27]
    v_mfma_f32_16x16x32_bf16 v[28:31], v[140:143], v[164:167], v[28:31]
    v_mfma_f32_16x16x32_bf16 v[32:35], v[140:143], v[168:171], v[32:35]
    v_mfma_f32_16x16x32_bf16 v[36:39], v[140:143], v[172:175], v[36:39]
    v_mfma_f32_16x16x32_bf16 v[40:43], v[144:147], v[160:163], v[40:43]
    v_mfma_f32_16x16x32_bf16 v[44:47], v[144:147], v[164:167], v[44:47]
    v_mfma_f32_16x16x32_bf16 v[48:51], v[144:147], v[168:171], v[48:51]
    v_mfma_f32_16x16x32_bf16 v[52:55], v[144:147], v[172:175], v[52:55]
    v_mfma_f32_16x16x32_bf16 v[56:59], v[148:151], v[160:163], v[56:59]
    v_mfma_f32_16x16x32_bf16 v[60:63], v[148:151], v[164:167], v[60:63]
    v_mfma_f32_16x16x32_bf16 v[64:67], v[148:151], v[168:171], v[64:67]
    v_mfma_f32_16x16x32_bf16 v[68:71], v[148:151], v[172:175], v[68:71]
    v_mfma_f32_16x16x32_bf16 v[72:75], v[152:155], v[160:163], v[72:75]
    v_mfma_f32_16x16x32_bf16 v[76:79], v[152:155], v[164:167], v[76:79]
    v_mfma_f32_16x16x32_bf16 v[80:83], v[152:155], v[168:171], v[80:83]
    v_mfma_f32_16x16x32_bf16 v[84:87], v[152:155], v[172:175], v[84:87]
    v_mfma_f32_16x16x32_bf16 v[88:91], v[156:159], v[160:163], v[88:91]
    v_mfma_f32_16x16x32_bf16 v[92:95], v[156:159], v[164:167], v[92:95]
    v_mfma_f32_16x16x32_bf16 v[96:99], v[156:159], v[168:171], v[96:99]
    v_mfma_f32_16x16x32_bf16 v[100:103], v[156:159], v[172:175], v[100:103]
    s_waitcnt vmcnt(9)
    s_barrier
    s_add_u32 m0, s24, 36864
    s_nop 0
    buffer_load_dwordx4 v5, s[8:11], s30 offen lds
    s_add_u32 s30, s30, 128
    s_add_u32 m0, s24, 40960
    s_nop 0
    buffer_load_dwordx4 v5, s[8:11], s31 offen lds
    s_add_u32 s31, s31, 128
    s_add_u32 m0, s24, 45056
    s_nop 0
    buffer_load_dwordx4 v5, s[8:11], s32 offen lds
    s_add_u32 s32, s32, 128
    s_add_u32 m0, s24, 49152
    s_nop 0
    buffer_load_dwordx4 v5, s[8:11], s33 offen lds
    s_add_u32 s33, s33, 128
    s_add_u32 m0, s24, 53248
    s_nop 0
    buffer_load_dwordx4 v5, s[8:11], s34 offen lds
    s_add_u32 s34, s34, 128
    s_add_u32 m0, s24, 57344
    s_nop 0
    buffer_load_dwordx4 v5, s[12:15], s35 offen lds
    s_add_u32 s35, s35, 128
    s_add_u32 m0, s24, 61440
    s_nop 0
    buffer_load_dwordx4 v5, s[12:15], s36 offen lds
    s_add_u32 s36, s36, 128
    s_add_u32 m0, s24, 65536
    s_nop 0
    buffer_load_dwordx4 v5, s[12:15], s37 offen lds
    s_add_u32 s37, s37, 128
    s_add_u32 m0, s24, 69632
    s_nop 0
    buffer_load_dwordx4 v5, s[12:15], s38 offen lds
    s_add_u32 s38, s38, 128
    ds_read_b128 v[104:107], v18 offset:0
    ds_read_b128 v[108:111], v18 offset:2048
    ds_read_b128 v[112:115], v18 offset:4096
    ds_read_b128 v[116:119], v18 offset:6144
    ds_read_b128 v[120:123], v18 offset:8192
    ds_read_b128 v[124:127], v20 offset:0
    ds_read_b128 v[128:131], v20 offset:2048
    ds_read_b128 v[132:135], v20 offset:4096
    ds_read_b128 v[136:139], v20 offset:6144
    ds_read_b128 v[140:143], v19 offset:0
    ds_read_b128 v[144:147], v19 offset:2048
    ds_read_b128 v[148:151], v19 offset:4096
    ds_read_b128 v[152:155], v19 offset:6144
    ds_read_b128 v[156:159], v19 offset:8192
    ds_read_b128 v[160:163], v21 offset:0
    ds_read_b128 v[164:167], v21 offset:2048
    ds_read_b128 v[168:171], v21 offset:4096
    ds_read_b128 v[172:175], v21 offset:6144
    s_waitcnt lgkmcnt(9)
    v_mfma_f32_16x16x32_bf16 v[24:27], v[104:107], v[124:127], v[24:27]
    v_mfma_f32_16x16x32_bf16 v[28:31], v[104:107], v[128:131], v[28:31]
    v_mfma_f32_16x16x32_bf16 v[32:35], v[104:107], v[132:135], v[32:35]
    v_mfma_f32_16x16x32_bf16 v[36:39], v[104:107], v[136:139], v[36:39]
    v_mfma_f32_16x16x32_bf16 v[40:43], v[108:111], v[124:127], v[40:43]
    v_mfma_f32_16x16x32_bf16 v[44:47], v[108:111], v[128:131], v[44:47]
    v_mfma_f32_16x16x32_bf16 v[48:51], v[108:111], v[132:135], v[48:51]
    v_mfma_f32_16x16x32_bf16 v[52:55], v[108:111], v[136:139], v[52:55]
    v_mfma_f32_16x16x32_bf16 v[56:59], v[112:115], v[124:127], v[56:59]
    v_mfma_f32_16x16x32_bf16 v[60:63], v[112:115], v[128:131], v[60:63]
    v_mfma_f32_16x16x32_bf16 v[64:67], v[112:115], v[132:135], v[64:67]
    v_mfma_f32_16x16x32_bf16 v[68:71], v[112:115], v[136:139], v[68:71]
    v_mfma_f32_16x16x32_bf16 v[72:75], v[116:119], v[124:127], v[72:75]
    v_mfma_f32_16x16x32_bf16 v[76:79], v[116:119], v[128:131], v[76:79]
    v_mfma_f32_16x16x32_bf16 v[80:83], v[116:119], v[132:135], v[80:83]
    v_mfma_f32_16x16x32_bf16 v[84:87], v[116:119], v[136:139], v[84:87]
    v_mfma_f32_16x16x32_bf16 v[88:91], v[120:123], v[124:127], v[88:91]
    v_mfma_f32_16x16x32_bf16 v[92:95], v[120:123], v[128:131], v[92:95]
    v_mfma_f32_16x16x32_bf16 v[96:99], v[120:123], v[132:135], v[96:99]
    v_mfma_f32_16x16x32_bf16 v[100:103], v[120:123], v[136:139], v[100:103]
    s_waitcnt lgkmcnt(0)
    v_mfma_f32_16x16x32_bf16 v[24:27], v[140:143], v[160:163], v[24:27]
    v_mfma_f32_16x16x32_bf16 v[28:31], v[140:143], v[164:167], v[28:31]
    v_mfma_f32_16x16x32_bf16 v[32:35], v[140:143], v[168:171], v[32:35]
    v_mfma_f32_16x16x32_bf16 v[36:39], v[140:143], v[172:175], v[36:39]
    v_mfma_f32_16x16x32_bf16 v[40:43], v[144:147], v[160:163], v[40:43]
    v_mfma_f32_16x16x32_bf16 v[44:47], v[144:147], v[164:167], v[44:47]
    v_mfma_f32_16x16x32_bf16 v[48:51], v[144:147], v[168:171], v[48:51]
    v_mfma_f32_16x16x32_bf16 v[52:55], v[144:147], v[172:175], v[52:55]
    v_mfma_f32_16x16x32_bf16 v[56:59], v[148:151], v[160:163], v[56:59]
    v_mfma_f32_16x16x32_bf16 v[60:63], v[148:151], v[164:167], v[60:63]
    v_mfma_f32_16x16x32_bf16 v[64:67], v[148:151], v[168:171], v[64:67]
    v_mfma_f32_16x16x32_bf16 v[68:71], v[148:151], v[172:175], v[68:71]
    v_mfma_f32_16x16x32_bf16 v[72:75], v[152:155], v[160:163], v[72:75]
    v_mfma_f32_16x16x32_bf16 v[76:79], v[152:155], v[164:167], v[76:79]
    v_mfma_f32_16x16x32_bf16 v[80:83], v[152:155], v[168:171], v[80:83]
    v_mfma_f32_16x16x32_bf16 v[84:87], v[152:155], v[172:175], v[84:87]
    v_mfma_f32_16x16x32_bf16 v[88:91], v[156:159], v[160:163], v[88:91]
    v_mfma_f32_16x16x32_bf16 v[92:95], v[156:159], v[164:167], v[92:95]
    v_mfma_f32_16x16x32_bf16 v[96:99], v[156:159], v[168:171], v[96:99]
    v_mfma_f32_16x16x32_bf16 v[100:103], v[156:159], v[172:175], v[100:103]
    s_waitcnt vmcnt(9)
    s_barrier
    s_add_u32 m0, s24, 73728
    s_nop 0
    buffer_load_dwordx4 v5, s[8:11], s30 offen lds
    s_add_u32 s30, s30, 128
    s_add_u32 m0, s24, 77824
    s_nop 0
    buffer_load_dwordx4 v5, s[8:11], s31 offen lds
    s_add_u32 s31, s31, 128
    s_add_u32 m0, s24, 81920
    s_nop 0
    buffer_load_dwordx4 v5, s[8:11], s32 offen lds
    s_add_u32 s32, s32, 128
    s_add_u32 m0, s24, 86016
    s_nop 0
    buffer_load_dwordx4 v5, s[8:11], s33 offen lds
    s_add_u32 s33, s33, 128
    s_add_u32 m0, s24, 90112
    s_nop 0
    buffer_load_dwordx4 v5, s[8:11], s34 offen lds
    s_add_u32 s34, s34, 128
    s_add_u32 m0, s24, 94208
    s_nop 0
    buffer_load_dwordx4 v5, s[12:15], s35 offen lds
    s_add_u32 s35, s35, 128
    s_add_u32 m0, s24, 98304
    s_nop 0
    buffer_load_dwordx4 v5, s[12:15], s36 offen lds
    s_add_u32 s36, s36, 128
    s_add_u32 m0, s24, 102400
    s_nop 0
    buffer_load_dwordx4 v5, s[12:15], s37 offen lds
    s_add_u32 s37, s37, 128
    s_add_u32 m0, s24, 106496
    s_nop 0
    buffer_load_dwordx4 v5, s[12:15], s38 offen lds
    s_add_u32 s38, s38, 128
    ds_read_b128 v[104:107], v10 offset:0
    ds_read_b128 v[108:111], v10 offset:2048
    ds_read_b128 v[112:115], v10 offset:4096
    ds_read_b128 v[116:119], v10 offset:6144
    ds_read_b128 v[120:123], v10 offset:8192
    ds_read_b128 v[124:127], v12 offset:0
    ds_read_b128 v[128:131], v12 offset:2048
    ds_read_b128 v[132:135], v12 offset:4096
    ds_read_b128 v[136:139], v12 offset:6144
    ds_read_b128 v[140:143], v11 offset:0
    ds_read_b128 v[144:147], v11 offset:2048
    ds_read_b128 v[148:151], v11 offset:4096
    ds_read_b128 v[152:155], v11 offset:6144
    ds_read_b128 v[156:159], v11 offset:8192
    ds_read_b128 v[160:163], v13 offset:0
    ds_read_b128 v[164:167], v13 offset:2048
    ds_read_b128 v[168:171], v13 offset:4096
    ds_read_b128 v[172:175], v13 offset:6144
    s_waitcnt lgkmcnt(9)
    v_mfma_f32_16x16x32_bf16 v[24:27], v[104:107], v[124:127], v[24:27]
    v_mfma_f32_16x16x32_bf16 v[28:31], v[104:107], v[128:131], v[28:31]
    v_mfma_f32_16x16x32_bf16 v[32:35], v[104:107], v[132:135], v[32:35]
    v_mfma_f32_16x16x32_bf16 v[36:39], v[104:107], v[136:139], v[36:39]
    v_mfma_f32_16x16x32_bf16 v[40:43], v[108:111], v[124:127], v[40:43]
    v_mfma_f32_16x16x32_bf16 v[44:47], v[108:111], v[128:131], v[44:47]
    v_mfma_f32_16x16x32_bf16 v[48:51], v[108:111], v[132:135], v[48:51]
    v_mfma_f32_16x16x32_bf16 v[52:55], v[108:111], v[136:139], v[52:55]
    v_mfma_f32_16x16x32_bf16 v[56:59], v[112:115], v[124:127], v[56:59]
    v_mfma_f32_16x16x32_bf16 v[60:63], v[112:115], v[128:131], v[60:63]
    v_mfma_f32_16x16x32_bf16 v[64:67], v[112:115], v[132:135], v[64:67]
    v_mfma_f32_16x16x32_bf16 v[68:71], v[112:115], v[136:139], v[68:71]
    v_mfma_f32_16x16x32_bf16 v[72:75], v[116:119], v[124:127], v[72:75]
    v_mfma_f32_16x16x32_bf16 v[76:79], v[116:119], v[128:131], v[76:79]
    v_mfma_f32_16x16x32_bf16 v[80:83], v[116:119], v[132:135], v[80:83]
    v_mfma_f32_16x16x32_bf16 v[84:87], v[116:119], v[136:139], v[84:87]
    v_mfma_f32_16x16x32_bf16 v[88:91], v[120:123], v[124:127], v[88:91]
    v_mfma_f32_16x16x32_bf16 v[92:95], v[120:123], v[128:131], v[92:95]
    v_mfma_f32_16x16x32_bf16 v[96:99], v[120:123], v[132:135], v[96:99]
    v_mfma_f32_16x16x32_bf16 v[100:103], v[120:123], v[136:139], v[100:103]
    s_waitcnt lgkmcnt(0)
    v_mfma_f32_16x16x32_bf16 v[24:27], v[140:143], v[160:163], v[24:27]
    v_mfma_f32_16x16x32_bf16 v[28:31], v[140:143], v[164:167], v[28:31]
    v_mfma_f32_16x16x32_bf16 v[32:35], v[140:143], v[168:171], v[32:35]
    v_mfma_f32_16x16x32_bf16 v[36:39], v[140:143], v[172:175], v[36:39]
    v_mfma_f32_16x16x32_bf16 v[40:43], v[144:147], v[160:163], v[40:43]
    v_mfma_f32_16x16x32_bf16 v[44:47], v[144:147], v[164:167], v[44:47]
    v_mfma_f32_16x16x32_bf16 v[48:51], v[144:147], v[168:171], v[48:51]
    v_mfma_f32_16x16x32_bf16 v[52:55], v[144:147], v[172:175], v[52:55]
    v_mfma_f32_16x16x32_bf16 v[56:59], v[148:151], v[160:163], v[56:59]
    v_mfma_f32_16x16x32_bf16 v[60:63], v[148:151], v[164:167], v[60:63]
    v_mfma_f32_16x16x32_bf16 v[64:67], v[148:151], v[168:171], v[64:67]
    v_mfma_f32_16x16x32_bf16 v[68:71], v[148:151], v[172:175], v[68:71]
    v_mfma_f32_16x16x32_bf16 v[72:75], v[152:155], v[160:163], v[72:75]
    v_mfma_f32_16x16x32_bf16 v[76:79], v[152:155], v[164:167], v[76:79]
    v_mfma_f32_16x16x32_bf16 v[80:83], v[152:155], v[168:171], v[80:83]
    v_mfma_f32_16x16x32_bf16 v[84:87], v[152:155], v[172:175], v[84:87]
    v_mfma_f32_16x16x32_bf16 v[88:91], v[156:159], v[160:163], v[88:91]
    v_mfma_f32_16x16x32_bf16 v[92:95], v[156:159], v[164:167], v[92:95]
    v_mfma_f32_16x16x32_bf16 v[96:99], v[156:159], v[168:171], v[96:99]
    v_mfma_f32_16x16x32_bf16 v[100:103], v[156:159], v[172:175], v[100:103]
    s_waitcnt vmcnt(9)
    s_barrier
    s_add_u32 m0, s24, 0
    s_nop 0
    buffer_load_dwordx4 v5, s[8:11], s30 offen lds
    s_add_u32 s30, s30, 128
    s_add_u32 m0, s24, 4096
    s_nop 0
    buffer_load_dwordx4 v5, s[8:11], s31 offen lds
    s_add_u32 s31, s31, 128
    s_add_u32 m0, s24, 8192
    s_nop 0
    buffer_load_dwordx4 v5, s[8:11], s32 offen lds
    s_add_u32 s32, s32, 128
    s_add_u32 m0, s24, 12288
    s_nop 0
    buffer_load_dwordx4 v5, s[8:11], s33 offen lds
    s_add_u32 s33, s33, 128
    s_add_u32 m0, s24, 16384
    s_nop 0
    buffer_load_dwordx4 v5, s[8:11], s34 offen lds
    s_add_u32 s34, s34, 128
    s_add_u32 m0, s24, 20480
    s_nop 0
    buffer_load_dwordx4 v5, s[12:15], s35 offen lds
    s_add_u32 s35, s35, 128
    s_add_u32 m0, s24, 24576
    s_nop 0
    buffer_load_dwordx4 v5, s[12:15], s36 offen lds
    s_add_u32 s36, s36, 128
    s_add_u32 m0, s24, 28672
    s_nop 0
    buffer_load_dwordx4 v5, s[12:15], s37 offen lds
    s_add_u32 s37, s37, 128
    s_add_u32 m0, s24, 32768
    s_nop 0
    buffer_load_dwordx4 v5, s[12:15], s38 offen lds
    s_add_u32 s38, s38, 128
    ds_read_b128 v[104:107], v14 offset:0
    ds_read_b128 v[108:111], v14 offset:2048
    ds_read_b128 v[112:115], v14 offset:4096
    ds_read_b128 v[116:119], v14 offset:6144
    ds_read_b128 v[120:123], v14 offset:8192
    ds_read_b128 v[124:127], v16 offset:0
    ds_read_b128 v[128:131], v16 offset:2048
    ds_read_b128 v[132:135], v16 offset:4096
    ds_read_b128 v[136:139], v16 offset:6144
    ds_read_b128 v[140:143], v15 offset:0
    ds_read_b128 v[144:147], v15 offset:2048
    ds_read_b128 v[148:151], v15 offset:4096
    ds_read_b128 v[152:155], v15 offset:6144
    ds_read_b128 v[156:159], v15 offset:8192
    ds_read_b128 v[160:163], v17 offset:0
    ds_read_b128 v[164:167], v17 offset:2048
    ds_read_b128 v[168:171], v17 offset:4096
    ds_read_b128 v[172:175], v17 offset:6144
    s_waitcnt lgkmcnt(9)
    v_mfma_f32_16x16x32_bf16 v[24:27], v[104:107], v[124:127], v[24:27]
    v_mfma_f32_16x16x32_bf16 v[28:31], v[104:107], v[128:131], v[28:31]
    v_mfma_f32_16x16x32_bf16 v[32:35], v[104:107], v[132:135], v[32:35]
    v_mfma_f32_16x16x32_bf16 v[36:39], v[104:107], v[136:139], v[36:39]
    v_mfma_f32_16x16x32_bf16 v[40:43], v[108:111], v[124:127], v[40:43]
    v_mfma_f32_16x16x32_bf16 v[44:47], v[108:111], v[128:131], v[44:47]
    v_mfma_f32_16x16x32_bf16 v[48:51], v[108:111], v[132:135], v[48:51]
    v_mfma_f32_16x16x32_bf16 v[52:55], v[108:111], v[136:139], v[52:55]
    v_mfma_f32_16x16x32_bf16 v[56:59], v[112:115], v[124:127], v[56:59]
    v_mfma_f32_16x16x32_bf16 v[60:63], v[112:115], v[128:131], v[60:63]
    v_mfma_f32_16x16x32_bf16 v[64:67], v[112:115], v[132:135], v[64:67]
    v_mfma_f32_16x16x32_bf16 v[68:71], v[112:115], v[136:139], v[68:71]
    v_mfma_f32_16x16x32_bf16 v[72:75], v[116:119], v[124:127], v[72:75]
    v_mfma_f32_16x16x32_bf16 v[76:79], v[116:119], v[128:131], v[76:79]
    v_mfma_f32_16x16x32_bf16 v[80:83], v[116:119], v[132:135], v[80:83]
    v_mfma_f32_16x16x32_bf16 v[84:87], v[116:119], v[136:139], v[84:87]
    v_mfma_f32_16x16x32_bf16 v[88:91], v[120:123], v[124:127], v[88:91]
    v_mfma_f32_16x16x32_bf16 v[92:95], v[120:123], v[128:131], v[92:95]
    v_mfma_f32_16x16x32_bf16 v[96:99], v[120:123], v[132:135], v[96:99]
    v_mfma_f32_16x16x32_bf16 v[100:103], v[120:123], v[136:139], v[100:103]
    s_waitcnt lgkmcnt(0)
    v_mfma_f32_16x16x32_bf16 v[24:27], v[140:143], v[160:163], v[24:27]
    v_mfma_f32_16x16x32_bf16 v[28:31], v[140:143], v[164:167], v[28:31]
    v_mfma_f32_16x16x32_bf16 v[32:35], v[140:143], v[168:171], v[32:35]
    v_mfma_f32_16x16x32_bf16 v[36:39], v[140:143], v[172:175], v[36:39]
    v_mfma_f32_16x16x32_bf16 v[40:43], v[144:147], v[160:163], v[40:43]
    v_mfma_f32_16x16x32_bf16 v[44:47], v[144:147], v[164:167], v[44:47]
    v_mfma_f32_16x16x32_bf16 v[48:51], v[144:147], v[168:171], v[48:51]
    v_mfma_f32_16x16x32_bf16 v[52:55], v[144:147], v[172:175], v[52:55]
    v_mfma_f32_16x16x32_bf16 v[56:59], v[148:151], v[160:163], v[56:59]
    v_mfma_f32_16x16x32_bf16 v[60:63], v[148:151], v[164:167], v[60:63]
    v_mfma_f32_16x16x32_bf16 v[64:67], v[148:151], v[168:171], v[64:67]
    v_mfma_f32_16x16x32_bf16 v[68:71], v[148:151], v[172:175], v[68:71]
    v_mfma_f32_16x16x32_bf16 v[72:75], v[152:155], v[160:163], v[72:75]
    v_mfma_f32_16x16x32_bf16 v[76:79], v[152:155], v[164:167], v[76:79]
    v_mfma_f32_16x16x32_bf16 v[80:83], v[152:155], v[168:171], v[80:83]
    v_mfma_f32_16x16x32_bf16 v[84:87], v[152:155], v[172:175], v[84:87]
    v_mfma_f32_16x16x32_bf16 v[88:91], v[156:159], v[160:163], v[88:91]
    v_mfma_f32_16x16x32_bf16 v[92:95], v[156:159], v[164:167], v[92:95]
    v_mfma_f32_16x16x32_bf16 v[96:99], v[156:159], v[168:171], v[96:99]
    v_mfma_f32_16x16x32_bf16 v[100:103], v[156:159], v[172:175], v[100:103]
    s_waitcnt vmcnt(9)
    s_barrier
    s_add_u32 m0, s24, 36864
    s_nop 0
    buffer_load_dwordx4 v5, s[8:11], s30 offen lds
    s_add_u32 s30, s30, 128
    s_add_u32 m0, s24, 40960
    s_nop 0
    buffer_load_dwordx4 v5, s[8:11], s31 offen lds
    s_add_u32 s31, s31, 128
    s_add_u32 m0, s24, 45056
    s_nop 0
    buffer_load_dwordx4 v5, s[8:11], s32 offen lds
    s_add_u32 s32, s32, 128
    s_add_u32 m0, s24, 49152
    s_nop 0
    buffer_load_dwordx4 v5, s[8:11], s33 offen lds
    s_add_u32 s33, s33, 128
    s_add_u32 m0, s24, 53248
    s_nop 0
    buffer_load_dwordx4 v5, s[8:11], s34 offen lds
    s_add_u32 s34, s34, 128
    s_add_u32 m0, s24, 57344
    s_nop 0
    buffer_load_dwordx4 v5, s[12:15], s35 offen lds
    s_add_u32 s35, s35, 128
    s_add_u32 m0, s24, 61440
    s_nop 0
    buffer_load_dwordx4 v5, s[12:15], s36 offen lds
    s_add_u32 s36, s36, 128
    s_add_u32 m0, s24, 65536
    s_nop 0
    buffer_load_dwordx4 v5, s[12:15], s37 offen lds
    s_add_u32 s37, s37, 128
    s_add_u32 m0, s24, 69632
    s_nop 0
    buffer_load_dwordx4 v5, s[12:15], s38 offen lds
    s_add_u32 s38, s38, 128
    ds_read_b128 v[104:107], v18 offset:0
    ds_read_b128 v[108:111], v18 offset:2048
    ds_read_b128 v[112:115], v18 offset:4096
    ds_read_b128 v[116:119], v18 offset:6144
    ds_read_b128 v[120:123], v18 offset:8192
    ds_read_b128 v[124:127], v20 offset:0
    ds_read_b128 v[128:131], v20 offset:2048
    ds_read_b128 v[132:135], v20 offset:4096
    ds_read_b128 v[136:139], v20 offset:6144
    ds_read_b128 v[140:143], v19 offset:0
    ds_read_b128 v[144:147], v19 offset:2048
    ds_read_b128 v[148:151], v19 offset:4096
    ds_read_b128 v[152:155], v19 offset:6144
    ds_read_b128 v[156:159], v19 offset:8192
    ds_read_b128 v[160:163], v21 offset:0
    ds_read_b128 v[164:167], v21 offset:2048
    ds_read_b128 v[168:171], v21 offset:4096
    ds_read_b128 v[172:175], v21 offset:6144
    s_waitcnt lgkmcnt(9)
    v_mfma_f32_16x16x32_bf16 v[24:27], v[104:107], v[124:127], v[24:27]
    v_mfma_f32_16x16x32_bf16 v[28:31], v[104:107], v[128:131], v[28:31]
    v_mfma_f32_16x16x32_bf16 v[32:35], v[104:107], v[132:135], v[32:35]
    v_mfma_f32_16x16x32_bf16 v[36:39], v[104:107], v[136:139], v[36:39]
    v_mfma_f32_16x16x32_bf16 v[40:43], v[108:111], v[124:127], v[40:43]
    v_mfma_f32_16x16x32_bf16 v[44:47], v[108:111], v[128:131], v[44:47]
    v_mfma_f32_16x16x32_bf16 v[48:51], v[108:111], v[132:135], v[48:51]
    v_mfma_f32_16x16x32_bf16 v[52:55], v[108:111], v[136:139], v[52:55]
    v_mfma_f32_16x16x32_bf16 v[56:59], v[112:115], v[124:127], v[56:59]
    v_mfma_f32_16x16x32_bf16 v[60:63], v[112:115], v[128:131], v[60:63]
    v_mfma_f32_16x16x32_bf16 v[64:67], v[112:115], v[132:135], v[64:67]
    v_mfma_f32_16x16x32_bf16 v[68:71], v[112:115], v[136:139], v[68:71]
    v_mfma_f32_16x16x32_bf16 v[72:75], v[116:119], v[124:127], v[72:75]
    v_mfma_f32_16x16x32_bf16 v[76:79], v[116:119], v[128:131], v[76:79]
    v_mfma_f32_16x16x32_bf16 v[80:83], v[116:119], v[132:135], v[80:83]
    v_mfma_f32_16x16x32_bf16 v[84:87], v[116:119], v[136:139], v[84:87]
    v_mfma_f32_16x16x32_bf16 v[88:91], v[120:123], v[124:127], v[88:91]
    v_mfma_f32_16x16x32_bf16 v[92:95], v[120:123], v[128:131], v[92:95]
    v_mfma_f32_16x16x32_bf16 v[96:99], v[120:123], v[132:135], v[96:99]
    v_mfma_f32_16x16x32_bf16 v[100:103], v[120:123], v[136:139], v[100:103]
    s_waitcnt lgkmcnt(0)
    v_mfma_f32_16x16x32_bf16 v[24:27], v[140:143], v[160:163], v[24:27]
    v_mfma_f32_16x16x32_bf16 v[28:31], v[140:143], v[164:167], v[28:31]
    v_mfma_f32_16x16x32_bf16 v[32:35], v[140:143], v[168:171], v[32:35]
    v_mfma_f32_16x16x32_bf16 v[36:39], v[140:143], v[172:175], v[36:39]
    v_mfma_f32_16x16x32_bf16 v[40:43], v[144:147], v[160:163], v[40:43]
    v_mfma_f32_16x16x32_bf16 v[44:47], v[144:147], v[164:167], v[44:47]
    v_mfma_f32_16x16x32_bf16 v[48:51], v[144:147], v[168:171], v[48:51]
    v_mfma_f32_16x16x32_bf16 v[52:55], v[144:147], v[172:175], v[52:55]
    v_mfma_f32_16x16x32_bf16 v[56:59], v[148:151], v[160:163], v[56:59]
    v_mfma_f32_16x16x32_bf16 v[60:63], v[148:151], v[164:167], v[60:63]
    v_mfma_f32_16x16x32_bf16 v[64:67], v[148:151], v[168:171], v[64:67]
    v_mfma_f32_16x16x32_bf16 v[68:71], v[148:151], v[172:175], v[68:71]
    v_mfma_f32_16x16x32_bf16 v[72:75], v[152:155], v[160:163], v[72:75]
    v_mfma_f32_16x16x32_bf16 v[76:79], v[152:155], v[164:167], v[76:79]
    v_mfma_f32_16x16x32_bf16 v[80:83], v[152:155], v[168:171], v[80:83]
    v_mfma_f32_16x16x32_bf16 v[84:87], v[152:155], v[172:175], v[84:87]
    v_mfma_f32_16x16x32_bf16 v[88:91], v[156:159], v[160:163], v[88:91]
    v_mfma_f32_16x16x32_bf16 v[92:95], v[156:159], v[164:167], v[92:95]
    v_mfma_f32_16x16x32_bf16 v[96:99], v[156:159], v[168:171], v[96:99]
    v_mfma_f32_16x16x32_bf16 v[100:103], v[156:159], v[172:175], v[100:103]
    s_waitcnt vmcnt(9)
    s_barrier
    s_add_u32 m0, s24, 73728
    s_nop 0
    buffer_load_dwordx4 v5, s[8:11], s30 offen lds
    s_add_u32 s30, s30, 128
    s_add_u32 m0, s24, 77824
    s_nop 0
    buffer_load_dwordx4 v5, s[8:11], s31 offen lds
    s_add_u32 s31, s31, 128
    s_add_u32 m0, s24, 81920
    s_nop 0
    buffer_load_dwordx4 v5, s[8:11], s32 offen lds
    s_add_u32 s32, s32, 128
    s_add_u32 m0, s24, 86016
    s_nop 0
    buffer_load_dwordx4 v5, s[8:11], s33 offen lds
    s_add_u32 s33, s33, 128
    s_add_u32 m0, s24, 90112
    s_nop 0
    buffer_load_dwordx4 v5, s[8:11], s34 offen lds
    s_add_u32 s34, s34, 128
    s_add_u32 m0, s24, 94208
    s_nop 0
    buffer_load_dwordx4 v5, s[12:15], s35 offen lds
    s_add_u32 s35, s35, 128
    s_add_u32 m0, s24, 98304
    s_nop 0
    buffer_load_dwordx4 v5, s[12:15], s36 offen lds
    s_add_u32 s36, s36, 128
    s_add_u32 m0, s24, 102400
    s_nop 0
    buffer_load_dwordx4 v5, s[12:15], s37 offen lds
    s_add_u32 s37, s37, 128
    s_add_u32 m0, s24, 106496
    s_nop 0
    buffer_load_dwordx4 v5, s[12:15], s38 offen lds
    s_add_u32 s38, s38, 128
    ds_read_b128 v[104:107], v10 offset:0
    ds_read_b128 v[108:111], v10 offset:2048
    ds_read_b128 v[112:115], v10 offset:4096
    ds_read_b128 v[116:119], v10 offset:6144
    ds_read_b128 v[120:123], v10 offset:8192
    ds_read_b128 v[124:127], v12 offset:0
    ds_read_b128 v[128:131], v12 offset:2048
    ds_read_b128 v[132:135], v12 offset:4096
    ds_read_b128 v[136:139], v12 offset:6144
    ds_read_b128 v[140:143], v11 offset:0
    ds_read_b128 v[144:147], v11 offset:2048
    ds_read_b128 v[148:151], v11 offset:4096
    ds_read_b128 v[152:155], v11 offset:6144
    ds_read_b128 v[156:159], v11 offset:8192
    ds_read_b128 v[160:163], v13 offset:0
    ds_read_b128 v[164:167], v13 offset:2048
    ds_read_b128 v[168:171], v13 offset:4096
    ds_read_b128 v[172:175], v13 offset:6144
    s_waitcnt lgkmcnt(9)
    v_mfma_f32_16x16x32_bf16 v[24:27], v[104:107], v[124:127], v[24:27]
    v_mfma_f32_16x16x32_bf16 v[28:31], v[104:107], v[128:131], v[28:31]
    v_mfma_f32_16x16x32_bf16 v[32:35], v[104:107], v[132:135], v[32:35]
    v_mfma_f32_16x16x32_bf16 v[36:39], v[104:107], v[136:139], v[36:39]
    v_mfma_f32_16x16x32_bf16 v[40:43], v[108:111], v[124:127], v[40:43]
    v_mfma_f32_16x16x32_bf16 v[44:47], v[108:111], v[128:131], v[44:47]
    v_mfma_f32_16x16x32_bf16 v[48:51], v[108:111], v[132:135], v[48:51]
    v_mfma_f32_16x16x32_bf16 v[52:55], v[108:111], v[136:139], v[52:55]
    v_mfma_f32_16x16x32_bf16 v[56:59], v[112:115], v[124:127], v[56:59]
    v_mfma_f32_16x16x32_bf16 v[60:63], v[112:115], v[128:131], v[60:63]
    v_mfma_f32_16x16x32_bf16 v[64:67], v[112:115], v[132:135], v[64:67]
    v_mfma_f32_16x16x32_bf16 v[68:71], v[112:115], v[136:139], v[68:71]
    v_mfma_f32_16x16x32_bf16 v[72:75], v[116:119], v[124:127], v[72:75]
    v_mfma_f32_16x16x32_bf16 v[76:79], v[116:119], v[128:131], v[76:79]
    v_mfma_f32_16x16x32_bf16 v[80:83], v[116:119], v[132:135], v[80:83]
    v_mfma_f32_16x16x32_bf16 v[84:87], v[116:119], v[136:139], v[84:87]
    v_mfma_f32_16x16x32_bf16 v[88:91], v[120:123], v[124:127], v[88:91]
    v_mfma_f32_16x16x32_bf16 v[92:95], v[120:123], v[128:131], v[92:95]
    v_mfma_f32_16x16x32_bf16 v[96:99], v[120:123], v[132:135], v[96:99]
    v_mfma_f32_16x16x32_bf16 v[100:103], v[120:123], v[136:139], v[100:103]
    s_waitcnt lgkmcnt(0)
    v_mfma_f32_16x16x32_bf16 v[24:27], v[140:143], v[160:163], v[24:27]
    v_mfma_f32_16x16x32_bf16 v[28:31], v[140:143], v[164:167], v[28:31]
    v_mfma_f32_16x16x32_bf16 v[32:35], v[140:143], v[168:171], v[32:35]
    v_mfma_f32_16x16x32_bf16 v[36:39], v[140:143], v[172:175], v[36:39]
    v_mfma_f32_16x16x32_bf16 v[40:43], v[144:147], v[160:163], v[40:43]
    v_mfma_f32_16x16x32_bf16 v[44:47], v[144:147], v[164:167], v[44:47]
    v_mfma_f32_16x16x32_bf16 v[48:51], v[144:147], v[168:171], v[48:51]
    v_mfma_f32_16x16x32_bf16 v[52:55], v[144:147], v[172:175], v[52:55]
    v_mfma_f32_16x16x32_bf16 v[56:59], v[148:151], v[160:163], v[56:59]
    v_mfma_f32_16x16x32_bf16 v[60:63], v[148:151], v[164:167], v[60:63]
    v_mfma_f32_16x16x32_bf16 v[64:67], v[148:151], v[168:171], v[64:67]
    v_mfma_f32_16x16x32_bf16 v[68:71], v[148:151], v[172:175], v[68:71]
    v_mfma_f32_16x16x32_bf16 v[72:75], v[152:155], v[160:163], v[72:75]
    v_mfma_f32_16x16x32_bf16 v[76:79], v[152:155], v[164:167], v[76:79]
    v_mfma_f32_16x16x32_bf16 v[80:83], v[152:155], v[168:171], v[80:83]
    v_mfma_f32_16x16x32_bf16 v[84:87], v[152:155], v[172:175], v[84:87]
    v_mfma_f32_16x16x32_bf16 v[88:91], v[156:159], v[160:163], v[88:91]
    v_mfma_f32_16x16x32_bf16 v[92:95], v[156:159], v[164:167], v[92:95]
    v_mfma_f32_16x16x32_bf16 v[96:99], v[156:159], v[168:171], v[96:99]
    v_mfma_f32_16x16x32_bf16 v[100:103], v[156:159], v[172:175], v[100:103]
    s_waitcnt vmcnt(9)
    s_barrier
    s_add_u32 m0, s24, 0
    s_nop 0
    buffer_load_dwordx4 v5, s[8:11], s30 offen lds
    s_add_u32 s30, s30, 128
    s_add_u32 m0, s24, 4096
    s_nop 0
    buffer_load_dwordx4 v5, s[8:11], s31 offen lds
    s_add_u32 s31, s31, 128
    s_add_u32 m0, s24, 8192
    s_nop 0
    buffer_load_dwordx4 v5, s[8:11], s32 offen lds
    s_add_u32 s32, s32, 128
    s_add_u32 m0, s24, 12288
    s_nop 0
    buffer_load_dwordx4 v5, s[8:11], s33 offen lds
    s_add_u32 s33, s33, 128
    s_add_u32 m0, s24, 16384
    s_nop 0
    buffer_load_dwordx4 v5, s[8:11], s34 offen lds
    s_add_u32 s34, s34, 128
    s_add_u32 m0, s24, 20480
    s_nop 0
    buffer_load_dwordx4 v5, s[12:15], s35 offen lds
    s_add_u32 s35, s35, 128
    s_add_u32 m0, s24, 24576
    s_nop 0
    buffer_load_dwordx4 v5, s[12:15], s36 offen lds
    s_add_u32 s36, s36, 128
    s_add_u32 m0, s24, 28672
    s_nop 0
    buffer_load_dwordx4 v5, s[12:15], s37 offen lds
    s_add_u32 s37, s37, 128
    s_add_u32 m0, s24, 32768
    s_nop 0
    buffer_load_dwordx4 v5, s[12:15], s38 offen lds
    s_add_u32 s38, s38, 128
    ds_read_b128 v[104:107], v14 offset:0
    ds_read_b128 v[108:111], v14 offset:2048
    ds_read_b128 v[112:115], v14 offset:4096
    ds_read_b128 v[116:119], v14 offset:6144
    ds_read_b128 v[120:123], v14 offset:8192
    ds_read_b128 v[124:127], v16 offset:0
    ds_read_b128 v[128:131], v16 offset:2048
    ds_read_b128 v[132:135], v16 offset:4096
    ds_read_b128 v[136:139], v16 offset:6144
    ds_read_b128 v[140:143], v15 offset:0
    ds_read_b128 v[144:147], v15 offset:2048
    ds_read_b128 v[148:151], v15 offset:4096
    ds_read_b128 v[152:155], v15 offset:6144
    ds_read_b128 v[156:159], v15 offset:8192
    ds_read_b128 v[160:163], v17 offset:0
    ds_read_b128 v[164:167], v17 offset:2048
    ds_read_b128 v[168:171], v17 offset:4096
    ds_read_b128 v[172:175], v17 offset:6144
    s_waitcnt lgkmcnt(9)
    v_mfma_f32_16x16x32_bf16 v[24:27], v[104:107], v[124:127], v[24:27]
    v_mfma_f32_16x16x32_bf16 v[28:31], v[104:107], v[128:131], v[28:31]
    v_mfma_f32_16x16x32_bf16 v[32:35], v[104:107], v[132:135], v[32:35]
    v_mfma_f32_16x16x32_bf16 v[36:39], v[104:107], v[136:139], v[36:39]
    v_mfma_f32_16x16x32_bf16 v[40:43], v[108:111], v[124:127], v[40:43]
    v_mfma_f32_16x16x32_bf16 v[44:47], v[108:111], v[128:131], v[44:47]
    v_mfma_f32_16x16x32_bf16 v[48:51], v[108:111], v[132:135], v[48:51]
    v_mfma_f32_16x16x32_bf16 v[52:55], v[108:111], v[136:139], v[52:55]
    v_mfma_f32_16x16x32_bf16 v[56:59], v[112:115], v[124:127], v[56:59]
    v_mfma_f32_16x16x32_bf16 v[60:63], v[112:115], v[128:131], v[60:63]
    v_mfma_f32_16x16x32_bf16 v[64:67], v[112:115], v[132:135], v[64:67]
    v_mfma_f32_16x16x32_bf16 v[68:71], v[112:115], v[136:139], v[68:71]
    v_mfma_f32_16x16x32_bf16 v[72:75], v[116:119], v[124:127], v[72:75]
    v_mfma_f32_16x16x32_bf16 v[76:79], v[116:119], v[128:131], v[76:79]
    v_mfma_f32_16x16x32_bf16 v[80:83], v[116:119], v[132:135], v[80:83]
    v_mfma_f32_16x16x32_bf16 v[84:87], v[116:119], v[136:139], v[84:87]
    v_mfma_f32_16x16x32_bf16 v[88:91], v[120:123], v[124:127], v[88:91]
    v_mfma_f32_16x16x32_bf16 v[92:95], v[120:123], v[128:131], v[92:95]
    v_mfma_f32_16x16x32_bf16 v[96:99], v[120:123], v[132:135], v[96:99]
    v_mfma_f32_16x16x32_bf16 v[100:103], v[120:123], v[136:139], v[100:103]
    s_waitcnt lgkmcnt(0)
    v_mfma_f32_16x16x32_bf16 v[24:27], v[140:143], v[160:163], v[24:27]
    v_mfma_f32_16x16x32_bf16 v[28:31], v[140:143], v[164:167], v[28:31]
    v_mfma_f32_16x16x32_bf16 v[32:35], v[140:143], v[168:171], v[32:35]
    v_mfma_f32_16x16x32_bf16 v[36:39], v[140:143], v[172:175], v[36:39]
    v_mfma_f32_16x16x32_bf16 v[40:43], v[144:147], v[160:163], v[40:43]
    v_mfma_f32_16x16x32_bf16 v[44:47], v[144:147], v[164:167], v[44:47]
    v_mfma_f32_16x16x32_bf16 v[48:51], v[144:147], v[168:171], v[48:51]
    v_mfma_f32_16x16x32_bf16 v[52:55], v[144:147], v[172:175], v[52:55]
    v_mfma_f32_16x16x32_bf16 v[56:59], v[148:151], v[160:163], v[56:59]
    v_mfma_f32_16x16x32_bf16 v[60:63], v[148:151], v[164:167], v[60:63]
    v_mfma_f32_16x16x32_bf16 v[64:67], v[148:151], v[168:171], v[64:67]
    v_mfma_f32_16x16x32_bf16 v[68:71], v[148:151], v[172:175], v[68:71]
    v_mfma_f32_16x16x32_bf16 v[72:75], v[152:155], v[160:163], v[72:75]
    v_mfma_f32_16x16x32_bf16 v[76:79], v[152:155], v[164:167], v[76:79]
    v_mfma_f32_16x16x32_bf16 v[80:83], v[152:155], v[168:171], v[80:83]
    v_mfma_f32_16x16x32_bf16 v[84:87], v[152:155], v[172:175], v[84:87]
    v_mfma_f32_16x16x32_bf16 v[88:91], v[156:159], v[160:163], v[88:91]
    v_mfma_f32_16x16x32_bf16 v[92:95], v[156:159], v[164:167], v[92:95]
    v_mfma_f32_16x16x32_bf16 v[96:99], v[156:159], v[168:171], v[96:99]
    v_mfma_f32_16x16x32_bf16 v[100:103], v[156:159], v[172:175], v[100:103]
    s_waitcnt vmcnt(9)
    s_barrier
    s_add_u32 m0, s24, 36864
    s_nop 0
    buffer_load_dwordx4 v5, s[8:11], s30 offen lds
    s_add_u32 s30, s30, 128
    s_add_u32 m0, s24, 40960
    s_nop 0
    buffer_load_dwordx4 v5, s[8:11], s31 offen lds
    s_add_u32 s31, s31, 128
    s_add_u32 m0, s24, 45056
    s_nop 0
    buffer_load_dwordx4 v5, s[8:11], s32 offen lds
    s_add_u32 s32, s32, 128
    s_add_u32 m0, s24, 49152
    s_nop 0
    buffer_load_dwordx4 v5, s[8:11], s33 offen lds
    s_add_u32 s33, s33, 128
    s_add_u32 m0, s24, 53248
    s_nop 0
    buffer_load_dwordx4 v5, s[8:11], s34 offen lds
    s_add_u32 s34, s34, 128
    s_add_u32 m0, s24, 57344
    s_nop 0
    buffer_load_dwordx4 v5, s[12:15], s35 offen lds
    s_add_u32 s35, s35, 128
    s_add_u32 m0, s24, 61440
    s_nop 0
    buffer_load_dwordx4 v5, s[12:15], s36 offen lds
    s_add_u32 s36, s36, 128
    s_add_u32 m0, s24, 65536
    s_nop 0
    buffer_load_dwordx4 v5, s[12:15], s37 offen lds
    s_add_u32 s37, s37, 128
    s_add_u32 m0, s24, 69632
    s_nop 0
    buffer_load_dwordx4 v5, s[12:15], s38 offen lds
    s_add_u32 s38, s38, 128
    ds_read_b128 v[104:107], v18 offset:0
    ds_read_b128 v[108:111], v18 offset:2048
    ds_read_b128 v[112:115], v18 offset:4096
    ds_read_b128 v[116:119], v18 offset:6144
    ds_read_b128 v[120:123], v18 offset:8192
    ds_read_b128 v[124:127], v20 offset:0
    ds_read_b128 v[128:131], v20 offset:2048
    ds_read_b128 v[132:135], v20 offset:4096
    ds_read_b128 v[136:139], v20 offset:6144
    ds_read_b128 v[140:143], v19 offset:0
    ds_read_b128 v[144:147], v19 offset:2048
    ds_read_b128 v[148:151], v19 offset:4096
    ds_read_b128 v[152:155], v19 offset:6144
    ds_read_b128 v[156:159], v19 offset:8192
    ds_read_b128 v[160:163], v21 offset:0
    ds_read_b128 v[164:167], v21 offset:2048
    ds_read_b128 v[168:171], v21 offset:4096
    ds_read_b128 v[172:175], v21 offset:6144
    s_waitcnt lgkmcnt(9)
    v_mfma_f32_16x16x32_bf16 v[24:27], v[104:107], v[124:127], v[24:27]
    v_mfma_f32_16x16x32_bf16 v[28:31], v[104:107], v[128:131], v[28:31]
    v_mfma_f32_16x16x32_bf16 v[32:35], v[104:107], v[132:135], v[32:35]
    v_mfma_f32_16x16x32_bf16 v[36:39], v[104:107], v[136:139], v[36:39]
    v_mfma_f32_16x16x32_bf16 v[40:43], v[108:111], v[124:127], v[40:43]
    v_mfma_f32_16x16x32_bf16 v[44:47], v[108:111], v[128:131], v[44:47]
    v_mfma_f32_16x16x32_bf16 v[48:51], v[108:111], v[132:135], v[48:51]
    v_mfma_f32_16x16x32_bf16 v[52:55], v[108:111], v[136:139], v[52:55]
    v_mfma_f32_16x16x32_bf16 v[56:59], v[112:115], v[124:127], v[56:59]
    v_mfma_f32_16x16x32_bf16 v[60:63], v[112:115], v[128:131], v[60:63]
    v_mfma_f32_16x16x32_bf16 v[64:67], v[112:115], v[132:135], v[64:67]
    v_mfma_f32_16x16x32_bf16 v[68:71], v[112:115], v[136:139], v[68:71]
    v_mfma_f32_16x16x32_bf16 v[72:75], v[116:119], v[124:127], v[72:75]
    v_mfma_f32_16x16x32_bf16 v[76:79], v[116:119], v[128:131], v[76:79]
    v_mfma_f32_16x16x32_bf16 v[80:83], v[116:119], v[132:135], v[80:83]
    v_mfma_f32_16x16x32_bf16 v[84:87], v[116:119], v[136:139], v[84:87]
    v_mfma_f32_16x16x32_bf16 v[88:91], v[120:123], v[124:127], v[88:91]
    v_mfma_f32_16x16x32_bf16 v[92:95], v[120:123], v[128:131], v[92:95]
    v_mfma_f32_16x16x32_bf16 v[96:99], v[120:123], v[132:135], v[96:99]
    v_mfma_f32_16x16x32_bf16 v[100:103], v[120:123], v[136:139], v[100:103]
    s_waitcnt lgkmcnt(0)
    v_mfma_f32_16x16x32_bf16 v[24:27], v[140:143], v[160:163], v[24:27]
    v_mfma_f32_16x16x32_bf16 v[28:31], v[140:143], v[164:167], v[28:31]
    v_mfma_f32_16x16x32_bf16 v[32:35], v[140:143], v[168:171], v[32:35]
    v_mfma_f32_16x16x32_bf16 v[36:39], v[140:143], v[172:175], v[36:39]
    v_mfma_f32_16x16x32_bf16 v[40:43], v[144:147], v[160:163], v[40:43]
    v_mfma_f32_16x16x32_bf16 v[44:47], v[144:147], v[164:167], v[44:47]
    v_mfma_f32_16x16x32_bf16 v[48:51], v[144:147], v[168:171], v[48:51]
    v_mfma_f32_16x16x32_bf16 v[52:55], v[144:147], v[172:175], v[52:55]
    v_mfma_f32_16x16x32_bf16 v[56:59], v[148:151], v[160:163], v[56:59]
    v_mfma_f32_16x16x32_bf16 v[60:63], v[148:151], v[164:167], v[60:63]
    v_mfma_f32_16x16x32_bf16 v[64:67], v[148:151], v[168:171], v[64:67]
    v_mfma_f32_16x16x32_bf16 v[68:71], v[148:151], v[172:175], v[68:71]
    v_mfma_f32_16x16x32_bf16 v[72:75], v[152:155], v[160:163], v[72:75]
    v_mfma_f32_16x16x32_bf16 v[76:79], v[152:155], v[164:167], v[76:79]
    v_mfma_f32_16x16x32_bf16 v[80:83], v[152:155], v[168:171], v[80:83]
    v_mfma_f32_16x16x32_bf16 v[84:87], v[152:155], v[172:175], v[84:87]
    v_mfma_f32_16x16x32_bf16 v[88:91], v[156:159], v[160:163], v[88:91]
    v_mfma_f32_16x16x32_bf16 v[92:95], v[156:159], v[164:167], v[92:95]
    v_mfma_f32_16x16x32_bf16 v[96:99], v[156:159], v[168:171], v[96:99]
    v_mfma_f32_16x16x32_bf16 v[100:103], v[156:159], v[172:175], v[100:103]
    s_waitcnt vmcnt(9)
    s_barrier
    s_add_u32 m0, s24, 73728
    s_nop 0
    buffer_load_dwordx4 v5, s[8:11], s30 offen lds
    s_add_u32 s30, s30, 128
    s_add_u32 m0, s24, 77824
    s_nop 0
    buffer_load_dwordx4 v5, s[8:11], s31 offen lds
    s_add_u32 s31, s31, 128
    s_add_u32 m0, s24, 81920
    s_nop 0
    buffer_load_dwordx4 v5, s[8:11], s32 offen lds
    s_add_u32 s32, s32, 128
    s_add_u32 m0, s24, 86016
    s_nop 0
    buffer_load_dwordx4 v5, s[8:11], s33 offen lds
    s_add_u32 s33, s33, 128
    s_add_u32 m0, s24, 90112
    s_nop 0
    buffer_load_dwordx4 v5, s[8:11], s34 offen lds
    s_add_u32 s34, s34, 128
    s_add_u32 m0, s24, 94208
    s_nop 0
    buffer_load_dwordx4 v5, s[12:15], s35 offen lds
    s_add_u32 s35, s35, 128
    s_add_u32 m0, s24, 98304
    s_nop 0
    buffer_load_dwordx4 v5, s[12:15], s36 offen lds
    s_add_u32 s36, s36, 128
    s_add_u32 m0, s24, 102400
    s_nop 0
    buffer_load_dwordx4 v5, s[12:15], s37 offen lds
    s_add_u32 s37, s37, 128
    s_add_u32 m0, s24, 106496
    s_nop 0
    buffer_load_dwordx4 v5, s[12:15], s38 offen lds
    s_add_u32 s38, s38, 128
    ds_read_b128 v[104:107], v10 offset:0
    ds_read_b128 v[108:111], v10 offset:2048
    ds_read_b128 v[112:115], v10 offset:4096
    ds_read_b128 v[116:119], v10 offset:6144
    ds_read_b128 v[120:123], v10 offset:8192
    ds_read_b128 v[124:127], v12 offset:0
    ds_read_b128 v[128:131], v12 offset:2048
    ds_read_b128 v[132:135], v12 offset:4096
    ds_read_b128 v[136:139], v12 offset:6144
    ds_read_b128 v[140:143], v11 offset:0
    ds_read_b128 v[144:147], v11 offset:2048
    ds_read_b128 v[148:151], v11 offset:4096
    ds_read_b128 v[152:155], v11 offset:6144
    ds_read_b128 v[156:159], v11 offset:8192
    ds_read_b128 v[160:163], v13 offset:0
    ds_read_b128 v[164:167], v13 offset:2048
    ds_read_b128 v[168:171], v13 offset:4096
    ds_read_b128 v[172:175], v13 offset:6144
    s_waitcnt lgkmcnt(9)
    v_mfma_f32_16x16x32_bf16 v[24:27], v[104:107], v[124:127], v[24:27]
    v_mfma_f32_16x16x32_bf16 v[28:31], v[104:107], v[128:131], v[28:31]
    v_mfma_f32_16x16x32_bf16 v[32:35], v[104:107], v[132:135], v[32:35]
    v_mfma_f32_16x16x32_bf16 v[36:39], v[104:107], v[136:139], v[36:39]
    v_mfma_f32_16x16x32_bf16 v[40:43], v[108:111], v[124:127], v[40:43]
    v_mfma_f32_16x16x32_bf16 v[44:47], v[108:111], v[128:131], v[44:47]
    v_mfma_f32_16x16x32_bf16 v[48:51], v[108:111], v[132:135], v[48:51]
    v_mfma_f32_16x16x32_bf16 v[52:55], v[108:111], v[136:139], v[52:55]
    v_mfma_f32_16x16x32_bf16 v[56:59], v[112:115], v[124:127], v[56:59]
    v_mfma_f32_16x16x32_bf16 v[60:63], v[112:115], v[128:131], v[60:63]
    v_mfma_f32_16x16x32_bf16 v[64:67], v[112:115], v[132:135], v[64:67]
    v_mfma_f32_16x16x32_bf16 v[68:71], v[112:115], v[136:139], v[68:71]
    v_mfma_f32_16x16x32_bf16 v[72:75], v[116:119], v[124:127], v[72:75]
    v_mfma_f32_16x16x32_bf16 v[76:79], v[116:119], v[128:131], v[76:79]
    v_mfma_f32_16x16x32_bf16 v[80:83], v[116:119], v[132:135], v[80:83]
    v_mfma_f32_16x16x32_bf16 v[84:87], v[116:119], v[136:139], v[84:87]
    v_mfma_f32_16x16x32_bf16 v[88:91], v[120:123], v[124:127], v[88:91]
    v_mfma_f32_16x16x32_bf16 v[92:95], v[120:123], v[128:131], v[92:95]
    v_mfma_f32_16x16x32_bf16 v[96:99], v[120:123], v[132:135], v[96:99]
    v_mfma_f32_16x16x32_bf16 v[100:103], v[120:123], v[136:139], v[100:103]
    s_waitcnt lgkmcnt(0)
    v_mfma_f32_16x16x32_bf16 v[24:27], v[140:143], v[160:163], v[24:27]
    v_mfma_f32_16x16x32_bf16 v[28:31], v[140:143], v[164:167], v[28:31]
    v_mfma_f32_16x16x32_bf16 v[32:35], v[140:143], v[168:171], v[32:35]
    v_mfma_f32_16x16x32_bf16 v[36:39], v[140:143], v[172:175], v[36:39]
    v_mfma_f32_16x16x32_bf16 v[40:43], v[144:147], v[160:163], v[40:43]
    v_mfma_f32_16x16x32_bf16 v[44:47], v[144:147], v[164:167], v[44:47]
    v_mfma_f32_16x16x32_bf16 v[48:51], v[144:147], v[168:171], v[48:51]
    v_mfma_f32_16x16x32_bf16 v[52:55], v[144:147], v[172:175], v[52:55]
    v_mfma_f32_16x16x32_bf16 v[56:59], v[148:151], v[160:163], v[56:59]
    v_mfma_f32_16x16x32_bf16 v[60:63], v[148:151], v[164:167], v[60:63]
    v_mfma_f32_16x16x32_bf16 v[64:67], v[148:151], v[168:171], v[64:67]
    v_mfma_f32_16x16x32_bf16 v[68:71], v[148:151], v[172:175], v[68:71]
    v_mfma_f32_16x16x32_bf16 v[72:75], v[152:155], v[160:163], v[72:75]
    v_mfma_f32_16x16x32_bf16 v[76:79], v[152:155], v[164:167], v[76:79]
    v_mfma_f32_16x16x32_bf16 v[80:83], v[152:155], v[168:171], v[80:83]
    v_mfma_f32_16x16x32_bf16 v[84:87], v[152:155], v[172:175], v[84:87]
    v_mfma_f32_16x16x32_bf16 v[88:91], v[156:159], v[160:163], v[88:91]
    v_mfma_f32_16x16x32_bf16 v[92:95], v[156:159], v[164:167], v[92:95]
    v_mfma_f32_16x16x32_bf16 v[96:99], v[156:159], v[168:171], v[96:99]
    v_mfma_f32_16x16x32_bf16 v[100:103], v[156:159], v[172:175], v[100:103]
    s_waitcnt vmcnt(9)
    s_barrier
    s_add_u32 m0, s24, 0
    s_nop 0
    buffer_load_dwordx4 v5, s[8:11], s30 offen lds
    s_add_u32 s30, s30, 128
    s_add_u32 m0, s24, 4096
    s_nop 0
    buffer_load_dwordx4 v5, s[8:11], s31 offen lds
    s_add_u32 s31, s31, 128
    s_add_u32 m0, s24, 8192
    s_nop 0
    buffer_load_dwordx4 v5, s[8:11], s32 offen lds
    s_add_u32 s32, s32, 128
    s_add_u32 m0, s24, 12288
    s_nop 0
    buffer_load_dwordx4 v5, s[8:11], s33 offen lds
    s_add_u32 s33, s33, 128
    s_add_u32 m0, s24, 16384
    s_nop 0
    buffer_load_dwordx4 v5, s[8:11], s34 offen lds
    s_add_u32 s34, s34, 128
    s_add_u32 m0, s24, 20480
    s_nop 0
    buffer_load_dwordx4 v5, s[12:15], s35 offen lds
    s_add_u32 s35, s35, 128
    s_add_u32 m0, s24, 24576
    s_nop 0
    buffer_load_dwordx4 v5, s[12:15], s36 offen lds
    s_add_u32 s36, s36, 128
    s_add_u32 m0, s24, 28672
    s_nop 0
    buffer_load_dwordx4 v5, s[12:15], s37 offen lds
    s_add_u32 s37, s37, 128
    s_add_u32 m0, s24, 32768
    s_nop 0
    buffer_load_dwordx4 v5, s[12:15], s38 offen lds
    s_add_u32 s38, s38, 128
    ds_read_b128 v[104:107], v14 offset:0
    ds_read_b128 v[108:111], v14 offset:2048
    ds_read_b128 v[112:115], v14 offset:4096
    ds_read_b128 v[116:119], v14 offset:6144
    ds_read_b128 v[120:123], v14 offset:8192
    ds_read_b128 v[124:127], v16 offset:0
    ds_read_b128 v[128:131], v16 offset:2048
    ds_read_b128 v[132:135], v16 offset:4096
    ds_read_b128 v[136:139], v16 offset:6144
    ds_read_b128 v[140:143], v15 offset:0
    ds_read_b128 v[144:147], v15 offset:2048
    ds_read_b128 v[148:151], v15 offset:4096
    ds_read_b128 v[152:155], v15 offset:6144
    ds_read_b128 v[156:159], v15 offset:8192
    ds_read_b128 v[160:163], v17 offset:0
    ds_read_b128 v[164:167], v17 offset:2048
    ds_read_b128 v[168:171], v17 offset:4096
    ds_read_b128 v[172:175], v17 offset:6144
    s_waitcnt lgkmcnt(9)
    v_mfma_f32_16x16x32_bf16 v[24:27], v[104:107], v[124:127], v[24:27]
    v_mfma_f32_16x16x32_bf16 v[28:31], v[104:107], v[128:131], v[28:31]
    v_mfma_f32_16x16x32_bf16 v[32:35], v[104:107], v[132:135], v[32:35]
    v_mfma_f32_16x16x32_bf16 v[36:39], v[104:107], v[136:139], v[36:39]
    v_mfma_f32_16x16x32_bf16 v[40:43], v[108:111], v[124:127], v[40:43]
    v_mfma_f32_16x16x32_bf16 v[44:47], v[108:111], v[128:131], v[44:47]
    v_mfma_f32_16x16x32_bf16 v[48:51], v[108:111], v[132:135], v[48:51]
    v_mfma_f32_16x16x32_bf16 v[52:55], v[108:111], v[136:139], v[52:55]
    v_mfma_f32_16x16x32_bf16 v[56:59], v[112:115], v[124:127], v[56:59]
    v_mfma_f32_16x16x32_bf16 v[60:63], v[112:115], v[128:131], v[60:63]
    v_mfma_f32_16x16x32_bf16 v[64:67], v[112:115], v[132:135], v[64:67]
    v_mfma_f32_16x16x32_bf16 v[68:71], v[112:115], v[136:139], v[68:71]
    v_mfma_f32_16x16x32_bf16 v[72:75], v[116:119], v[124:127], v[72:75]
    v_mfma_f32_16x16x32_bf16 v[76:79], v[116:119], v[128:131], v[76:79]
    v_mfma_f32_16x16x32_bf16 v[80:83], v[116:119], v[132:135], v[80:83]
    v_mfma_f32_16x16x32_bf16 v[84:87], v[116:119], v[136:139], v[84:87]
    v_mfma_f32_16x16x32_bf16 v[88:91], v[120:123], v[124:127], v[88:91]
    v_mfma_f32_16x16x32_bf16 v[92:95], v[120:123], v[128:131], v[92:95]
    v_mfma_f32_16x16x32_bf16 v[96:99], v[120:123], v[132:135], v[96:99]
    v_mfma_f32_16x16x32_bf16 v[100:103], v[120:123], v[136:139], v[100:103]
    s_waitcnt lgkmcnt(0)
    v_mfma_f32_16x16x32_bf16 v[24:27], v[140:143], v[160:163], v[24:27]
    v_mfma_f32_16x16x32_bf16 v[28:31], v[140:143], v[164:167], v[28:31]
    v_mfma_f32_16x16x32_bf16 v[32:35], v[140:143], v[168:171], v[32:35]
    v_mfma_f32_16x16x32_bf16 v[36:39], v[140:143], v[172:175], v[36:39]
    v_mfma_f32_16x16x32_bf16 v[40:43], v[144:147], v[160:163], v[40:43]
    v_mfma_f32_16x16x32_bf16 v[44:47], v[144:147], v[164:167], v[44:47]
    v_mfma_f32_16x16x32_bf16 v[48:51], v[144:147], v[168:171], v[48:51]
    v_mfma_f32_16x16x32_bf16 v[52:55], v[144:147], v[172:175], v[52:55]
    v_mfma_f32_16x16x32_bf16 v[56:59], v[148:151], v[160:163], v[56:59]
    v_mfma_f32_16x16x32_bf16 v[60:63], v[148:151], v[164:167], v[60:63]
    v_mfma_f32_16x16x32_bf16 v[64:67], v[148:151], v[168:171], v[64:67]
    v_mfma_f32_16x16x32_bf16 v[68:71], v[148:151], v[172:175], v[68:71]
    v_mfma_f32_16x16x32_bf16 v[72:75], v[152:155], v[160:163], v[72:75]
    v_mfma_f32_16x16x32_bf16 v[76:79], v[152:155], v[164:167], v[76:79]
    v_mfma_f32_16x16x32_bf16 v[80:83], v[152:155], v[168:171], v[80:83]
    v_mfma_f32_16x16x32_bf16 v[84:87], v[152:155], v[172:175], v[84:87]
    v_mfma_f32_16x16x32_bf16 v[88:91], v[156:159], v[160:163], v[88:91]
    v_mfma_f32_16x16x32_bf16 v[92:95], v[156:159], v[164:167], v[92:95]
    v_mfma_f32_16x16x32_bf16 v[96:99], v[156:159], v[168:171], v[96:99]
    v_mfma_f32_16x16x32_bf16 v[100:103], v[156:159], v[172:175], v[100:103]
    s_waitcnt vmcnt(9)
    s_barrier
    s_add_u32 m0, s24, 36864
    s_nop 0
    buffer_load_dwordx4 v5, s[8:11], s30 offen lds
    s_add_u32 s30, s30, 128
    s_add_u32 m0, s24, 40960
    s_nop 0
    buffer_load_dwordx4 v5, s[8:11], s31 offen lds
    s_add_u32 s31, s31, 128
    s_add_u32 m0, s24, 45056
    s_nop 0
    buffer_load_dwordx4 v5, s[8:11], s32 offen lds
    s_add_u32 s32, s32, 128
    s_add_u32 m0, s24, 49152
    s_nop 0
    buffer_load_dwordx4 v5, s[8:11], s33 offen lds
    s_add_u32 s33, s33, 128
    s_add_u32 m0, s24, 53248
    s_nop 0
    buffer_load_dwordx4 v5, s[8:11], s34 offen lds
    s_add_u32 s34, s34, 128
    s_add_u32 m0, s24, 57344
    s_nop 0
    buffer_load_dwordx4 v5, s[12:15], s35 offen lds
    s_add_u32 s35, s35, 128
    s_add_u32 m0, s24, 61440
    s_nop 0
    buffer_load_dwordx4 v5, s[12:15], s36 offen lds
    s_add_u32 s36, s36, 128
    s_add_u32 m0, s24, 65536
    s_nop 0
    buffer_load_dwordx4 v5, s[12:15], s37 offen lds
    s_add_u32 s37, s37, 128
    s_add_u32 m0, s24, 69632
    s_nop 0
    buffer_load_dwordx4 v5, s[12:15], s38 offen lds
    s_add_u32 s38, s38, 128
    ds_read_b128 v[104:107], v18 offset:0
    ds_read_b128 v[108:111], v18 offset:2048
    ds_read_b128 v[112:115], v18 offset:4096
    ds_read_b128 v[116:119], v18 offset:6144
    ds_read_b128 v[120:123], v18 offset:8192
    ds_read_b128 v[124:127], v20 offset:0
    ds_read_b128 v[128:131], v20 offset:2048
    ds_read_b128 v[132:135], v20 offset:4096
    ds_read_b128 v[136:139], v20 offset:6144
    ds_read_b128 v[140:143], v19 offset:0
    ds_read_b128 v[144:147], v19 offset:2048
    ds_read_b128 v[148:151], v19 offset:4096
    ds_read_b128 v[152:155], v19 offset:6144
    ds_read_b128 v[156:159], v19 offset:8192
    ds_read_b128 v[160:163], v21 offset:0
    ds_read_b128 v[164:167], v21 offset:2048
    ds_read_b128 v[168:171], v21 offset:4096
    ds_read_b128 v[172:175], v21 offset:6144
    s_waitcnt lgkmcnt(9)
    v_mfma_f32_16x16x32_bf16 v[24:27], v[104:107], v[124:127], v[24:27]
    v_mfma_f32_16x16x32_bf16 v[28:31], v[104:107], v[128:131], v[28:31]
    v_mfma_f32_16x16x32_bf16 v[32:35], v[104:107], v[132:135], v[32:35]
    v_mfma_f32_16x16x32_bf16 v[36:39], v[104:107], v[136:139], v[36:39]
    v_mfma_f32_16x16x32_bf16 v[40:43], v[108:111], v[124:127], v[40:43]
    v_mfma_f32_16x16x32_bf16 v[44:47], v[108:111], v[128:131], v[44:47]
    v_mfma_f32_16x16x32_bf16 v[48:51], v[108:111], v[132:135], v[48:51]
    v_mfma_f32_16x16x32_bf16 v[52:55], v[108:111], v[136:139], v[52:55]
    v_mfma_f32_16x16x32_bf16 v[56:59], v[112:115], v[124:127], v[56:59]
    v_mfma_f32_16x16x32_bf16 v[60:63], v[112:115], v[128:131], v[60:63]
    v_mfma_f32_16x16x32_bf16 v[64:67], v[112:115], v[132:135], v[64:67]
    v_mfma_f32_16x16x32_bf16 v[68:71], v[112:115], v[136:139], v[68:71]
    v_mfma_f32_16x16x32_bf16 v[72:75], v[116:119], v[124:127], v[72:75]
    v_mfma_f32_16x16x32_bf16 v[76:79], v[116:119], v[128:131], v[76:79]
    v_mfma_f32_16x16x32_bf16 v[80:83], v[116:119], v[132:135], v[80:83]
    v_mfma_f32_16x16x32_bf16 v[84:87], v[116:119], v[136:139], v[84:87]
    v_mfma_f32_16x16x32_bf16 v[88:91], v[120:123], v[124:127], v[88:91]
    v_mfma_f32_16x16x32_bf16 v[92:95], v[120:123], v[128:131], v[92:95]
    v_mfma_f32_16x16x32_bf16 v[96:99], v[120:123], v[132:135], v[96:99]
    v_mfma_f32_16x16x32_bf16 v[100:103], v[120:123], v[136:139], v[100:103]
    s_waitcnt lgkmcnt(0)
    v_mfma_f32_16x16x32_bf16 v[24:27], v[140:143], v[160:163], v[24:27]
    v_mfma_f32_16x16x32_bf16 v[28:31], v[140:143], v[164:167], v[28:31]
    v_mfma_f32_16x16x32_bf16 v[32:35], v[140:143], v[168:171], v[32:35]
    v_mfma_f32_16x16x32_bf16 v[36:39], v[140:143], v[172:175], v[36:39]
    v_mfma_f32_16x16x32_bf16 v[40:43], v[144:147], v[160:163], v[40:43]
    v_mfma_f32_16x16x32_bf16 v[44:47], v[144:147], v[164:167], v[44:47]
    v_mfma_f32_16x16x32_bf16 v[48:51], v[144:147], v[168:171], v[48:51]
    v_mfma_f32_16x16x32_bf16 v[52:55], v[144:147], v[172:175], v[52:55]
    v_mfma_f32_16x16x32_bf16 v[56:59], v[148:151], v[160:163], v[56:59]
    v_mfma_f32_16x16x32_bf16 v[60:63], v[148:151], v[164:167], v[60:63]
    v_mfma_f32_16x16x32_bf16 v[64:67], v[148:151], v[168:171], v[64:67]
    v_mfma_f32_16x16x32_bf16 v[68:71], v[148:151], v[172:175], v[68:71]
    v_mfma_f32_16x16x32_bf16 v[72:75], v[152:155], v[160:163], v[72:75]
    v_mfma_f32_16x16x32_bf16 v[76:79], v[152:155], v[164:167], v[76:79]
    v_mfma_f32_16x16x32_bf16 v[80:83], v[152:155], v[168:171], v[80:83]
    v_mfma_f32_16x16x32_bf16 v[84:87], v[152:155], v[172:175], v[84:87]
    v_mfma_f32_16x16x32_bf16 v[88:91], v[156:159], v[160:163], v[88:91]
    v_mfma_f32_16x16x32_bf16 v[92:95], v[156:159], v[164:167], v[92:95]
    v_mfma_f32_16x16x32_bf16 v[96:99], v[156:159], v[168:171], v[96:99]
    v_mfma_f32_16x16x32_bf16 v[100:103], v[156:159], v[172:175], v[100:103]
    s_waitcnt vmcnt(9)
    s_barrier
    s_add_u32 m0, s24, 73728
    s_nop 0
    buffer_load_dwordx4 v5, s[8:11], s30 offen lds
    s_add_u32 s30, s30, 128
    s_add_u32 m0, s24, 77824
    s_nop 0
    buffer_load_dwordx4 v5, s[8:11], s31 offen lds
    s_add_u32 s31, s31, 128
    s_add_u32 m0, s24, 81920
    s_nop 0
    buffer_load_dwordx4 v5, s[8:11], s32 offen lds
    s_add_u32 s32, s32, 128
    s_add_u32 m0, s24, 86016
    s_nop 0
    buffer_load_dwordx4 v5, s[8:11], s33 offen lds
    s_add_u32 s33, s33, 128
    s_add_u32 m0, s24, 90112
    s_nop 0
    buffer_load_dwordx4 v5, s[8:11], s34 offen lds
    s_add_u32 s34, s34, 128
    s_add_u32 m0, s24, 94208
    s_nop 0
    buffer_load_dwordx4 v5, s[12:15], s35 offen lds
    s_add_u32 s35, s35, 128
    s_add_u32 m0, s24, 98304
    s_nop 0
    buffer_load_dwordx4 v5, s[12:15], s36 offen lds
    s_add_u32 s36, s36, 128
    s_add_u32 m0, s24, 102400
    s_nop 0
    buffer_load_dwordx4 v5, s[12:15], s37 offen lds
    s_add_u32 s37, s37, 128
    s_add_u32 m0, s24, 106496
    s_nop 0
    buffer_load_dwordx4 v5, s[12:15], s38 offen lds
    s_add_u32 s38, s38, 128
    ds_read_b128 v[104:107], v10 offset:0
    ds_read_b128 v[108:111], v10 offset:2048
    ds_read_b128 v[112:115], v10 offset:4096
    ds_read_b128 v[116:119], v10 offset:6144
    ds_read_b128 v[120:123], v10 offset:8192
    ds_read_b128 v[124:127], v12 offset:0
    ds_read_b128 v[128:131], v12 offset:2048
    ds_read_b128 v[132:135], v12 offset:4096
    ds_read_b128 v[136:139], v12 offset:6144
    ds_read_b128 v[140:143], v11 offset:0
    ds_read_b128 v[144:147], v11 offset:2048
    ds_read_b128 v[148:151], v11 offset:4096
    ds_read_b128 v[152:155], v11 offset:6144
    ds_read_b128 v[156:159], v11 offset:8192
    ds_read_b128 v[160:163], v13 offset:0
    ds_read_b128 v[164:167], v13 offset:2048
    ds_read_b128 v[168:171], v13 offset:4096
    ds_read_b128 v[172:175], v13 offset:6144
    s_waitcnt lgkmcnt(9)
    v_mfma_f32_16x16x32_bf16 v[24:27], v[104:107], v[124:127], v[24:27]
    v_mfma_f32_16x16x32_bf16 v[28:31], v[104:107], v[128:131], v[28:31]
    v_mfma_f32_16x16x32_bf16 v[32:35], v[104:107], v[132:135], v[32:35]
    v_mfma_f32_16x16x32_bf16 v[36:39], v[104:107], v[136:139], v[36:39]
    v_mfma_f32_16x16x32_bf16 v[40:43], v[108:111], v[124:127], v[40:43]
    v_mfma_f32_16x16x32_bf16 v[44:47], v[108:111], v[128:131], v[44:47]
    v_mfma_f32_16x16x32_bf16 v[48:51], v[108:111], v[132:135], v[48:51]
    v_mfma_f32_16x16x32_bf16 v[52:55], v[108:111], v[136:139], v[52:55]
    v_mfma_f32_16x16x32_bf16 v[56:59], v[112:115], v[124:127], v[56:59]
    v_mfma_f32_16x16x32_bf16 v[60:63], v[112:115], v[128:131], v[60:63]
    v_mfma_f32_16x16x32_bf16 v[64:67], v[112:115], v[132:135], v[64:67]
    v_mfma_f32_16x16x32_bf16 v[68:71], v[112:115], v[136:139], v[68:71]
    v_mfma_f32_16x16x32_bf16 v[72:75], v[116:119], v[124:127], v[72:75]
    v_mfma_f32_16x16x32_bf16 v[76:79], v[116:119], v[128:131], v[76:79]
    v_mfma_f32_16x16x32_bf16 v[80:83], v[116:119], v[132:135], v[80:83]
    v_mfma_f32_16x16x32_bf16 v[84:87], v[116:119], v[136:139], v[84:87]
    v_mfma_f32_16x16x32_bf16 v[88:91], v[120:123], v[124:127], v[88:91]
    v_mfma_f32_16x16x32_bf16 v[92:95], v[120:123], v[128:131], v[92:95]
    v_mfma_f32_16x16x32_bf16 v[96:99], v[120:123], v[132:135], v[96:99]
    v_mfma_f32_16x16x32_bf16 v[100:103], v[120:123], v[136:139], v[100:103]
    s_waitcnt lgkmcnt(0)
    v_mfma_f32_16x16x32_bf16 v[24:27], v[140:143], v[160:163], v[24:27]
    v_mfma_f32_16x16x32_bf16 v[28:31], v[140:143], v[164:167], v[28:31]
    v_mfma_f32_16x16x32_bf16 v[32:35], v[140:143], v[168:171], v[32:35]
    v_mfma_f32_16x16x32_bf16 v[36:39], v[140:143], v[172:175], v[36:39]
    v_mfma_f32_16x16x32_bf16 v[40:43], v[144:147], v[160:163], v[40:43]
    v_mfma_f32_16x16x32_bf16 v[44:47], v[144:147], v[164:167], v[44:47]
    v_mfma_f32_16x16x32_bf16 v[48:51], v[144:147], v[168:171], v[48:51]
    v_mfma_f32_16x16x32_bf16 v[52:55], v[144:147], v[172:175], v[52:55]
    v_mfma_f32_16x16x32_bf16 v[56:59], v[148:151], v[160:163], v[56:59]
    v_mfma_f32_16x16x32_bf16 v[60:63], v[148:151], v[164:167], v[60:63]
    v_mfma_f32_16x16x32_bf16 v[64:67], v[148:151], v[168:171], v[64:67]
    v_mfma_f32_16x16x32_bf16 v[68:71], v[148:151], v[172:175], v[68:71]
    v_mfma_f32_16x16x32_bf16 v[72:75], v[152:155], v[160:163], v[72:75]
    v_mfma_f32_16x16x32_bf16 v[76:79], v[152:155], v[164:167], v[76:79]
    v_mfma_f32_16x16x32_bf16 v[80:83], v[152:155], v[168:171], v[80:83]
    v_mfma_f32_16x16x32_bf16 v[84:87], v[152:155], v[172:175], v[84:87]
    v_mfma_f32_16x16x32_bf16 v[88:91], v[156:159], v[160:163], v[88:91]
    v_mfma_f32_16x16x32_bf16 v[92:95], v[156:159], v[164:167], v[92:95]
    v_mfma_f32_16x16x32_bf16 v[96:99], v[156:159], v[168:171], v[96:99]
    v_mfma_f32_16x16x32_bf16 v[100:103], v[156:159], v[172:175], v[100:103]
    s_waitcnt vmcnt(9)
    s_barrier
    s_add_u32 m0, s24, 0
    s_nop 0
    buffer_load_dwordx4 v5, s[8:11], s30 offen lds
    s_add_u32 s30, s30, 128
    s_add_u32 m0, s24, 4096
    s_nop 0
    buffer_load_dwordx4 v5, s[8:11], s31 offen lds
    s_add_u32 s31, s31, 128
    s_add_u32 m0, s24, 8192
    s_nop 0
    buffer_load_dwordx4 v5, s[8:11], s32 offen lds
    s_add_u32 s32, s32, 128
    s_add_u32 m0, s24, 12288
    s_nop 0
    buffer_load_dwordx4 v5, s[8:11], s33 offen lds
    s_add_u32 s33, s33, 128
    s_add_u32 m0, s24, 16384
    s_nop 0
    buffer_load_dwordx4 v5, s[8:11], s34 offen lds
    s_add_u32 s34, s34, 128
    s_add_u32 m0, s24, 20480
    s_nop 0
    buffer_load_dwordx4 v5, s[12:15], s35 offen lds
    s_add_u32 s35, s35, 128
    s_add_u32 m0, s24, 24576
    s_nop 0
    buffer_load_dwordx4 v5, s[12:15], s36 offen lds
    s_add_u32 s36, s36, 128
    s_add_u32 m0, s24, 28672
    s_nop 0
    buffer_load_dwordx4 v5, s[12:15], s37 offen lds
    s_add_u32 s37, s37, 128
    s_add_u32 m0, s24, 32768
    s_nop 0
    buffer_load_dwordx4 v5, s[12:15], s38 offen lds
    s_add_u32 s38, s38, 128
    ds_read_b128 v[104:107], v14 offset:0
    ds_read_b128 v[108:111], v14 offset:2048
    ds_read_b128 v[112:115], v14 offset:4096
    ds_read_b128 v[116:119], v14 offset:6144
    ds_read_b128 v[120:123], v14 offset:8192
    ds_read_b128 v[124:127], v16 offset:0
    ds_read_b128 v[128:131], v16 offset:2048
    ds_read_b128 v[132:135], v16 offset:4096
    ds_read_b128 v[136:139], v16 offset:6144
    ds_read_b128 v[140:143], v15 offset:0
    ds_read_b128 v[144:147], v15 offset:2048
    ds_read_b128 v[148:151], v15 offset:4096
    ds_read_b128 v[152:155], v15 offset:6144
    ds_read_b128 v[156:159], v15 offset:8192
    ds_read_b128 v[160:163], v17 offset:0
    ds_read_b128 v[164:167], v17 offset:2048
    ds_read_b128 v[168:171], v17 offset:4096
    ds_read_b128 v[172:175], v17 offset:6144
    s_waitcnt lgkmcnt(9)
    v_mfma_f32_16x16x32_bf16 v[24:27], v[104:107], v[124:127], v[24:27]
    v_mfma_f32_16x16x32_bf16 v[28:31], v[104:107], v[128:131], v[28:31]
    v_mfma_f32_16x16x32_bf16 v[32:35], v[104:107], v[132:135], v[32:35]
    v_mfma_f32_16x16x32_bf16 v[36:39], v[104:107], v[136:139], v[36:39]
    v_mfma_f32_16x16x32_bf16 v[40:43], v[108:111], v[124:127], v[40:43]
    v_mfma_f32_16x16x32_bf16 v[44:47], v[108:111], v[128:131], v[44:47]
    v_mfma_f32_16x16x32_bf16 v[48:51], v[108:111], v[132:135], v[48:51]
    v_mfma_f32_16x16x32_bf16 v[52:55], v[108:111], v[136:139], v[52:55]
    v_mfma_f32_16x16x32_bf16 v[56:59], v[112:115], v[124:127], v[56:59]
    v_mfma_f32_16x16x32_bf16 v[60:63], v[112:115], v[128:131], v[60:63]
    v_mfma_f32_16x16x32_bf16 v[64:67], v[112:115], v[132:135], v[64:67]
    v_mfma_f32_16x16x32_bf16 v[68:71], v[112:115], v[136:139], v[68:71]
    v_mfma_f32_16x16x32_bf16 v[72:75], v[116:119], v[124:127], v[72:75]
    v_mfma_f32_16x16x32_bf16 v[76:79], v[116:119], v[128:131], v[76:79]
    v_mfma_f32_16x16x32_bf16 v[80:83], v[116:119], v[132:135], v[80:83]
    v_mfma_f32_16x16x32_bf16 v[84:87], v[116:119], v[136:139], v[84:87]
    v_mfma_f32_16x16x32_bf16 v[88:91], v[120:123], v[124:127], v[88:91]
    v_mfma_f32_16x16x32_bf16 v[92:95], v[120:123], v[128:131], v[92:95]
    v_mfma_f32_16x16x32_bf16 v[96:99], v[120:123], v[132:135], v[96:99]
    v_mfma_f32_16x16x32_bf16 v[100:103], v[120:123], v[136:139], v[100:103]
    s_waitcnt lgkmcnt(0)
    v_mfma_f32_16x16x32_bf16 v[24:27], v[140:143], v[160:163], v[24:27]
    v_mfma_f32_16x16x32_bf16 v[28:31], v[140:143], v[164:167], v[28:31]
    v_mfma_f32_16x16x32_bf16 v[32:35], v[140:143], v[168:171], v[32:35]
    v_mfma_f32_16x16x32_bf16 v[36:39], v[140:143], v[172:175], v[36:39]
    v_mfma_f32_16x16x32_bf16 v[40:43], v[144:147], v[160:163], v[40:43]
    v_mfma_f32_16x16x32_bf16 v[44:47], v[144:147], v[164:167], v[44:47]
    v_mfma_f32_16x16x32_bf16 v[48:51], v[144:147], v[168:171], v[48:51]
    v_mfma_f32_16x16x32_bf16 v[52:55], v[144:147], v[172:175], v[52:55]
    v_mfma_f32_16x16x32_bf16 v[56:59], v[148:151], v[160:163], v[56:59]
    v_mfma_f32_16x16x32_bf16 v[60:63], v[148:151], v[164:167], v[60:63]
    v_mfma_f32_16x16x32_bf16 v[64:67], v[148:151], v[168:171], v[64:67]
    v_mfma_f32_16x16x32_bf16 v[68:71], v[148:151], v[172:175], v[68:71]
    v_mfma_f32_16x16x32_bf16 v[72:75], v[152:155], v[160:163], v[72:75]
    v_mfma_f32_16x16x32_bf16 v[76:79], v[152:155], v[164:167], v[76:79]
    v_mfma_f32_16x16x32_bf16 v[80:83], v[152:155], v[168:171], v[80:83]
    v_mfma_f32_16x16x32_bf16 v[84:87], v[152:155], v[172:175], v[84:87]
    v_mfma_f32_16x16x32_bf16 v[88:91], v[156:159], v[160:163], v[88:91]
    v_mfma_f32_16x16x32_bf16 v[92:95], v[156:159], v[164:167], v[92:95]
    v_mfma_f32_16x16x32_bf16 v[96:99], v[156:159], v[168:171], v[96:99]
    v_mfma_f32_16x16x32_bf16 v[100:103], v[156:159], v[172:175], v[100:103]
    s_waitcnt vmcnt(9)
    s_barrier
    ds_read_b128 v[104:107], v18 offset:0
    ds_read_b128 v[108:111], v18 offset:2048
    ds_read_b128 v[112:115], v18 offset:4096
    ds_read_b128 v[116:119], v18 offset:6144
    ds_read_b128 v[120:123], v18 offset:8192
    ds_read_b128 v[124:127], v20 offset:0
    ds_read_b128 v[128:131], v20 offset:2048
    ds_read_b128 v[132:135], v20 offset:4096
    ds_read_b128 v[136:139], v20 offset:6144
    ds_read_b128 v[140:143], v19 offset:0
    ds_read_b128 v[144:147], v19 offset:2048
    ds_read_b128 v[148:151], v19 offset:4096
    ds_read_b128 v[152:155], v19 offset:6144
    ds_read_b128 v[156:159], v19 offset:8192
    ds_read_b128 v[160:163], v21 offset:0
    ds_read_b128 v[164:167], v21 offset:2048
    ds_read_b128 v[168:171], v21 offset:4096
    ds_read_b128 v[172:175], v21 offset:6144
    s_waitcnt lgkmcnt(9)
    v_mfma_f32_16x16x32_bf16 v[24:27], v[104:107], v[124:127], v[24:27]
    v_mfma_f32_16x16x32_bf16 v[28:31], v[104:107], v[128:131], v[28:31]
    v_mfma_f32_16x16x32_bf16 v[32:35], v[104:107], v[132:135], v[32:35]
    v_mfma_f32_16x16x32_bf16 v[36:39], v[104:107], v[136:139], v[36:39]
    v_mfma_f32_16x16x32_bf16 v[40:43], v[108:111], v[124:127], v[40:43]
    v_mfma_f32_16x16x32_bf16 v[44:47], v[108:111], v[128:131], v[44:47]
    v_mfma_f32_16x16x32_bf16 v[48:51], v[108:111], v[132:135], v[48:51]
    v_mfma_f32_16x16x32_bf16 v[52:55], v[108:111], v[136:139], v[52:55]
    v_mfma_f32_16x16x32_bf16 v[56:59], v[112:115], v[124:127], v[56:59]
    v_mfma_f32_16x16x32_bf16 v[60:63], v[112:115], v[128:131], v[60:63]
    v_mfma_f32_16x16x32_bf16 v[64:67], v[112:115], v[132:135], v[64:67]
    v_mfma_f32_16x16x32_bf16 v[68:71], v[112:115], v[136:139], v[68:71]
    v_mfma_f32_16x16x32_bf16 v[72:75], v[116:119], v[124:127], v[72:75]
    v_mfma_f32_16x16x32_bf16 v[76:79], v[116:119], v[128:131], v[76:79]
    v_mfma_f32_16x16x32_bf16 v[80:83], v[116:119], v[132:135], v[80:83]
    v_mfma_f32_16x16x32_bf16 v[84:87], v[116:119], v[136:139], v[84:87]
    v_mfma_f32_16x16x32_bf16 v[88:91], v[120:123], v[124:127], v[88:91]
    v_mfma_f32_16x16x32_bf16 v[92:95], v[120:123], v[128:131], v[92:95]
    v_mfma_f32_16x16x32_bf16 v[96:99], v[120:123], v[132:135], v[96:99]
    v_mfma_f32_16x16x32_bf16 v[100:103], v[120:123], v[136:139], v[100:103]
    s_waitcnt lgkmcnt(0)
    v_mfma_f32_16x16x32_bf16 v[24:27], v[140:143], v[160:163], v[24:27]
    v_mfma_f32_16x16x32_bf16 v[28:31], v[140:143], v[164:167], v[28:31]
    v_mfma_f32_16x16x32_bf16 v[32:35], v[140:143], v[168:171], v[32:35]
    v_mfma_f32_16x16x32_bf16 v[36:39], v[140:143], v[172:175], v[36:39]
    v_mfma_f32_16x16x32_bf16 v[40:43], v[144:147], v[160:163], v[40:43]
    v_mfma_f32_16x16x32_bf16 v[44:47], v[144:147], v[164:167], v[44:47]
    v_mfma_f32_16x16x32_bf16 v[48:51], v[144:147], v[168:171], v[48:51]
    v_mfma_f32_16x16x32_bf16 v[52:55], v[144:147], v[172:175], v[52:55]
    v_mfma_f32_16x16x32_bf16 v[56:59], v[148:151], v[160:163], v[56:59]
    v_mfma_f32_16x16x32_bf16 v[60:63], v[148:151], v[164:167], v[60:63]
    v_mfma_f32_16x16x32_bf16 v[64:67], v[148:151], v[168:171], v[64:67]
    v_mfma_f32_16x16x32_bf16 v[68:71], v[148:151], v[172:175], v[68:71]
    v_mfma_f32_16x16x32_bf16 v[72:75], v[152:155], v[160:163], v[72:75]
    v_mfma_f32_16x16x32_bf16 v[76:79], v[152:155], v[164:167], v[76:79]
    v_mfma_f32_16x16x32_bf16 v[80:83], v[152:155], v[168:171], v[80:83]
    v_mfma_f32_16x16x32_bf16 v[84:87], v[152:155], v[172:175], v[84:87]
    v_mfma_f32_16x16x32_bf16 v[88:91], v[156:159], v[160:163], v[88:91]
    v_mfma_f32_16x16x32_bf16 v[92:95], v[156:159], v[164:167], v[92:95]
    v_mfma_f32_16x16x32_bf16 v[96:99], v[156:159], v[168:171], v[96:99]
    v_mfma_f32_16x16x32_bf16 v[100:103], v[156:159], v[172:175], v[100:103]
    s_waitcnt vmcnt(0)
    s_barrier
    ds_read_b128 v[104:107], v10 offset:0
    ds_read_b128 v[108:111], v10 offset:2048
    ds_read_b128 v[112:115], v10 offset:4096
    ds_read_b128 v[116:119], v10 offset:6144
    ds_read_b128 v[120:123], v10 offset:8192
    ds_read_b128 v[124:127], v12 offset:0
    ds_read_b128 v[128:131], v12 offset:2048
    ds_read_b128 v[132:135], v12 offset:4096
    ds_read_b128 v[136:139], v12 offset:6144
    ds_read_b128 v[140:143], v11 offset:0
    ds_read_b128 v[144:147], v11 offset:2048
    ds_read_b128 v[148:151], v11 offset:4096
    ds_read_b128 v[152:155], v11 offset:6144
    ds_read_b128 v[156:159], v11 offset:8192
    ds_read_b128 v[160:163], v13 offset:0
    ds_read_b128 v[164:167], v13 offset:2048
    ds_read_b128 v[168:171], v13 offset:4096
    ds_read_b128 v[172:175], v13 offset:6144
    s_waitcnt lgkmcnt(9)
    v_mfma_f32_16x16x32_bf16 v[24:27], v[104:107], v[124:127], v[24:27]
    v_mfma_f32_16x16x32_bf16 v[28:31], v[104:107], v[128:131], v[28:31]
    v_mfma_f32_16x16x32_bf16 v[32:35], v[104:107], v[132:135], v[32:35]
    v_mfma_f32_16x16x32_bf16 v[36:39], v[104:107], v[136:139], v[36:39]
    v_mfma_f32_16x16x32_bf16 v[40:43], v[108:111], v[124:127], v[40:43]
    v_mfma_f32_16x16x32_bf16 v[44:47], v[108:111], v[128:131], v[44:47]
    v_mfma_f32_16x16x32_bf16 v[48:51], v[108:111], v[132:135], v[48:51]
    v_mfma_f32_16x16x32_bf16 v[52:55], v[108:111], v[136:139], v[52:55]
    v_mfma_f32_16x16x32_bf16 v[56:59], v[112:115], v[124:127], v[56:59]
    v_mfma_f32_16x16x32_bf16 v[60:63], v[112:115], v[128:131], v[60:63]
    v_mfma_f32_16x16x32_bf16 v[64:67], v[112:115], v[132:135], v[64:67]
    v_mfma_f32_16x16x32_bf16 v[68:71], v[112:115], v[136:139], v[68:71]
    v_mfma_f32_16x16x32_bf16 v[72:75], v[116:119], v[124:127], v[72:75]
    v_mfma_f32_16x16x32_bf16 v[76:79], v[116:119], v[128:131], v[76:79]
    v_mfma_f32_16x16x32_bf16 v[80:83], v[116:119], v[132:135], v[80:83]
    v_mfma_f32_16x16x32_bf16 v[84:87], v[116:119], v[136:139], v[84:87]
    v_mfma_f32_16x16x32_bf16 v[88:91], v[120:123], v[124:127], v[88:91]
    v_mfma_f32_16x16x32_bf16 v[92:95], v[120:123], v[128:131], v[92:95]
    v_mfma_f32_16x16x32_bf16 v[96:99], v[120:123], v[132:135], v[96:99]
    v_mfma_f32_16x16x32_bf16 v[100:103], v[120:123], v[136:139], v[100:103]
    s_waitcnt lgkmcnt(0)
    v_mfma_f32_16x16x32_bf16 v[24:27], v[140:143], v[160:163], v[24:27]
    v_mfma_f32_16x16x32_bf16 v[28:31], v[140:143], v[164:167], v[28:31]
    v_mfma_f32_16x16x32_bf16 v[32:35], v[140:143], v[168:171], v[32:35]
    v_mfma_f32_16x16x32_bf16 v[36:39], v[140:143], v[172:175], v[36:39]
    v_mfma_f32_16x16x32_bf16 v[40:43], v[144:147], v[160:163], v[40:43]
    v_mfma_f32_16x16x32_bf16 v[44:47], v[144:147], v[164:167], v[44:47]
    v_mfma_f32_16x16x32_bf16 v[48:51], v[144:147], v[168:171], v[48:51]
    v_mfma_f32_16x16x32_bf16 v[52:55], v[144:147], v[172:175], v[52:55]
    v_mfma_f32_16x16x32_bf16 v[56:59], v[148:151], v[160:163], v[56:59]
    v_mfma_f32_16x16x32_bf16 v[60:63], v[148:151], v[164:167], v[60:63]
    v_mfma_f32_16x16x32_bf16 v[64:67], v[148:151], v[168:171], v[64:67]
    v_mfma_f32_16x16x32_bf16 v[68:71], v[148:151], v[172:175], v[68:71]
    v_mfma_f32_16x16x32_bf16 v[72:75], v[152:155], v[160:163], v[72:75]
    v_mfma_f32_16x16x32_bf16 v[76:79], v[152:155], v[164:167], v[76:79]
    v_mfma_f32_16x16x32_bf16 v[80:83], v[152:155], v[168:171], v[80:83]
    v_mfma_f32_16x16x32_bf16 v[84:87], v[152:155], v[172:175], v[84:87]
    v_mfma_f32_16x16x32_bf16 v[88:91], v[156:159], v[160:163], v[88:91]
    v_mfma_f32_16x16x32_bf16 v[92:95], v[156:159], v[164:167], v[92:95]
    v_mfma_f32_16x16x32_bf16 v[96:99], v[156:159], v[168:171], v[96:99]
    v_mfma_f32_16x16x32_bf16 v[100:103], v[156:159], v[172:175], v[100:103]
    s_nop 7
    s_nop 7
    v_mul_u32_u24 v6, 2560, v6
    v_lshl_add_u32 v6, v7, 4, v6
    s_mul_i32 s27, s51, 5242880
    s_mul_i32 s28, s52, 327680
    s_add_u32 s27, s27, s28
    s_mul_i32 s28, s26, 163840
    s_add_u32 s27, s27, s28
    s_mul_i32 s28, s53, 640
    s_add_u32 s27, s27, s28
    s_mul_i32 s28, s25, 320
    s_add_u32 s27, s27, s28
    v_add_u32 v6, s27, v6
    v_add_u32 v4, 0, v6
    buffer_store_dwordx4 v[24:27], v4, s[16:19], 0 offen offset:0
    buffer_store_dwordx4 v[40:43], v4, s[16:19], 0 offen offset:64
    buffer_store_dwordx4 v[56:59], v4, s[16:19], 0 offen offset:128
    buffer_store_dwordx4 v[72:75], v4, s[16:19], 0 offen offset:192
    buffer_store_dwordx4 v[88:91], v4, s[16:19], 0 offen offset:256
    v_add_u32 v4, 40960, v6
    buffer_store_dwordx4 v[28:31], v4, s[16:19], 0 offen offset:0
    buffer_store_dwordx4 v[44:47], v4, s[16:19], 0 offen offset:64
    buffer_store_dwordx4 v[60:63], v4, s[16:19], 0 offen offset:128
    buffer_store_dwordx4 v[76:79], v4, s[16:19], 0 offen offset:192
    buffer_store_dwordx4 v[92:95], v4, s[16:19], 0 offen offset:256
    v_add_u32 v4, 81920, v6
    buffer_store_dwordx4 v[32:35], v4, s[16:19], 0 offen offset:0
    buffer_store_dwordx4 v[48:51], v4, s[16:19], 0 offen offset:64
    buffer_store_dwordx4 v[64:67], v4, s[16:19], 0 offen offset:128
    buffer_store_dwordx4 v[80:83], v4, s[16:19], 0 offen offset:192
    buffer_store_dwordx4 v[96:99], v4, s[16:19], 0 offen offset:256
    v_add_u32 v4, 122880, v6
    buffer_store_dwordx4 v[36:39], v4, s[16:19], 0 offen offset:0
    buffer_store_dwordx4 v[52:55], v4, s[16:19], 0 offen offset:64
    buffer_store_dwordx4 v[68:71], v4, s[16:19], 0 offen offset:128
    buffer_store_dwordx4 v[84:87], v4, s[16:19], 0 offen offset:192
    buffer_store_dwordx4 v[100:103], v4, s[16:19], 0 offen offset:256
L_k2_end:
    s_endpgm
.globl k3_kernel
.p2align 8
.type k3_kernel,@function
k3_kernel:
    s_cmp_ge_u32 s2, 640
    s_cbranch_scc1 L_k3_end
    s_load_dwordx2 s[4:5], s[0:1], 88
    s_load_dwordx2 s[48:49], s[0:1], 104
    s_lshl_b32 s3, s2, 8
    v_add_u32 v1, s3, v0
    s_waitcnt lgkmcnt(0)
    s_add_u32 s16, s48, 8388608
    s_addc_u32 s17, s49, 0
    s_mov_b32 s18, 20971520
    s_mov_b32 s19, 0x00020000
    s_mov_b32 s8, s4
    s_mov_b32 s9, s5
    s_mov_b32 s10, 5242880
    s_mov_b32 s11, 0x00020000
    v_lshlrev_b32 v2, 5, v1
    v_add_u32 v3, 0, v2
    buffer_load_dwordx4 v[8:11], v3, s[16:19], 0 offen
    buffer_load_dwordx4 v[12:15], v3, s[16:19], 0 offen offset:16
    v_add_u32 v3, 5242880, v2
    buffer_load_dwordx4 v[16:19], v3, s[16:19], 0 offen
    buffer_load_dwordx4 v[20:23], v3, s[16:19], 0 offen offset:16
    v_add_u32 v3, 10485760, v2
    buffer_load_dwordx4 v[24:27], v3, s[16:19], 0 offen
    buffer_load_dwordx4 v[28:31], v3, s[16:19], 0 offen offset:16
    v_add_u32 v3, 15728640, v2
    buffer_load_dwordx4 v[32:35], v3, s[16:19], 0 offen
    buffer_load_dwordx4 v[36:39], v3, s[16:19], 0 offen offset:16
    s_mov_b32 s20, 0x3333334
    v_mul_hi_u32 v4, v1, s20
    v_mul_u32_u24 v5, 80, v4
    v_sub_u32 v5, v1, v5
    v_mul_u32_u24 v4, 2560, v4
    v_lshl_add_u32 v4, v5, 4, v4
    v_add_u32 v4, 1280, v4
    s_waitcnt vmcnt(0)
    v_add_f32 v8, v8, v16
    v_cvt_pk_bf16_f32 v8, v8, v8
    v_lshlrev_b32 v8, 16, v8
    v_add_f32 v24, v24, v32
    v_cvt_pk_bf16_f32 v24, v24, v24
    v_lshlrev_b32 v24, 16, v24
    v_sub_f32 v8, v8, v24
    v_add_f32 v9, v9, v17
    v_cvt_pk_bf16_f32 v9, v9, v9
    v_lshlrev_b32 v9, 16, v9
    v_add_f32 v25, v25, v33
    v_cvt_pk_bf16_f32 v25, v25, v25
    v_lshlrev_b32 v25, 16, v25
    v_sub_f32 v9, v9, v25
    v_add_f32 v10, v10, v18
    v_cvt_pk_bf16_f32 v10, v10, v10
    v_lshlrev_b32 v10, 16, v10
    v_add_f32 v26, v26, v34
    v_cvt_pk_bf16_f32 v26, v26, v26
    v_lshlrev_b32 v26, 16, v26
    v_sub_f32 v10, v10, v26
    v_add_f32 v11, v11, v19
    v_cvt_pk_bf16_f32 v11, v11, v11
    v_lshlrev_b32 v11, 16, v11
    v_add_f32 v27, v27, v35
    v_cvt_pk_bf16_f32 v27, v27, v27
    v_lshlrev_b32 v27, 16, v27
    v_sub_f32 v11, v11, v27
    v_add_f32 v12, v12, v20
    v_cvt_pk_bf16_f32 v12, v12, v12
    v_lshlrev_b32 v12, 16, v12
    v_add_f32 v28, v28, v36
    v_cvt_pk_bf16_f32 v28, v28, v28
    v_lshlrev_b32 v28, 16, v28
    v_sub_f32 v12, v12, v28
    v_add_f32 v13, v13, v21
    v_cvt_pk_bf16_f32 v13, v13, v13
    v_lshlrev_b32 v13, 16, v13
    v_add_f32 v29, v29, v37
    v_cvt_pk_bf16_f32 v29, v29, v29
    v_lshlrev_b32 v29, 16, v29
    v_sub_f32 v13, v13, v29
    v_add_f32 v14, v14, v22
    v_cvt_pk_bf16_f32 v14, v14, v14
    v_lshlrev_b32 v14, 16, v14
    v_add_f32 v30, v30, v38
    v_cvt_pk_bf16_f32 v30, v30, v30
    v_lshlrev_b32 v30, 16, v30
    v_sub_f32 v14, v14, v30
    v_add_f32 v15, v15, v23
    v_cvt_pk_bf16_f32 v15, v15, v15
    v_lshlrev_b32 v15, 16, v15
    v_add_f32 v31, v31, v39
    v_cvt_pk_bf16_f32 v31, v31, v31
    v_lshlrev_b32 v31, 16, v31
    v_sub_f32 v15, v15, v31
    v_cvt_pk_bf16_f32 v40, v8, v9
    v_cvt_pk_bf16_f32 v41, v10, v11
    v_cvt_pk_bf16_f32 v42, v12, v13
    v_cvt_pk_bf16_f32 v43, v14, v15
    buffer_store_dwordx4 v[40:43], v4, s[8:11], 0 offen
L_k3_end:
    s_endpgm
.section .rodata,"a"
.p2align 6
.amdhsa_kernel k1_kernel
  .amdhsa_next_free_vgpr 256
  .amdhsa_next_free_sgpr 102
  .amdhsa_accum_offset 256
  .amdhsa_group_segment_fixed_size 0
  .amdhsa_kernarg_size 112
  .amdhsa_user_sgpr_count 2
  .amdhsa_user_sgpr_kernarg_segment_ptr 1
  .amdhsa_system_sgpr_workgroup_id_x 1
.end_amdhsa_kernel
.p2align 6
.amdhsa_kernel k2_kernel
  .amdhsa_next_free_vgpr 256
  .amdhsa_next_free_sgpr 102
  .amdhsa_accum_offset 256
  .amdhsa_group_segment_fixed_size 0
  .amdhsa_kernarg_size 112
  .amdhsa_user_sgpr_count 2
  .amdhsa_user_sgpr_kernarg_segment_ptr 1
  .amdhsa_system_sgpr_workgroup_id_x 1
.end_amdhsa_kernel
.p2align 6
.amdhsa_kernel k3_kernel
  .amdhsa_next_free_vgpr 256
  .amdhsa_next_free_sgpr 102
  .amdhsa_accum_offset 256
  .amdhsa_group_segment_fixed_size 0
  .amdhsa_kernarg_size 112
  .amdhsa_user_sgpr_count 2
  .amdhsa_user_sgpr_kernarg_segment_ptr 1
  .amdhsa_system_sgpr_workgroup_id_x 1
.end_amdhsa_kernel
```
